```python
import torch

def _softmax(x, axis=-1):
    return torch.softmax(x, dim=axis)
def _gelu(x):
    return torch.nn.functional.gelu(x, approximate="tanh")
def _silu(x):
    return torch.nn.functional.silu(x)
def _sigmoid(x):
    return torch.sigmoid(x)
def _layernorm(x, axis=-1, eps=1e-5):
    m = x.mean(dim=axis, keepdim=True)
    v = x.var(dim=axis, keepdim=True, unbiased=False)
    return (x - m) / torch.sqrt(v + eps)
def _scatter_add(tgt, idx, src, axis=0):
    return tgt.clone().index_add_(axis, idx, src)
def _segment_sum(src, seg, n):
    out = torch.zeros((n,) + src.shape[1:], dtype=src.dtype)
    return out.index_add_(0, seg, src)
def _pad(x, pw):
    flat = tuple(v for pair in reversed(pw) for v in pair)
    return torch.nn.functional.pad(x, flat)

kernel_name = 'sequential_preLN__sliding_local_dilated__glu_gated_swiglu__prompt'

def setup_inputs():

    _w = (lambda a: (lambda t: t.to(torch.bfloat16) if t.is_floating_point() else t)(torch.as_tensor(a)))
    def _A_setup():
        B, S, D = 1, 2048, 512
        return {
            "x": _w((lambda *s: torch.randn(*s, dtype=torch.bfloat16) * 0.05)(B, S, D)),
            "wqkv": _w((lambda *s: torch.randn(*s, dtype=torch.bfloat16) * 0.05)(D, 3 * D)),
            "wo": _w((lambda *s: torch.randn(*s, dtype=torch.bfloat16) * 0.05)(D, D)),
        }
    _A_in = _A_setup()

    def _B_setup():
        B, S, D, F = 1, 2048, 512, 1792
        return {
            "x": _w((lambda *s: torch.randn(*s, dtype=torch.bfloat16) * 0.05)(B, S, D)),
            "w1": _w((lambda *s: torch.randn(*s, dtype=torch.bfloat16) * 0.8)(D, F) * (2.0 / D) ** 0.5),
            "w3": _w((lambda *s: torch.randn(*s, dtype=torch.bfloat16) * 0.8)(D, F) * (2.0 / D) ** 0.5),
            "w2": _w((lambda *s: torch.randn(*s, dtype=torch.bfloat16) * 0.8)(F, D) * (2.0 / F) ** 0.5),
        }
    _B_in = _B_setup()

    return {
        "A_x": _A_in["x"],
        "A_wqkv": _A_in["wqkv"],
        "A_wo": _A_in["wo"],
        "B_x": _B_in["x"],
        "B_w1": _B_in["w1"],
        "B_w3": _B_in["w3"],
        "B_w2": _B_in["w2"],
    }

def reference(A_x, A_wqkv, A_wo, B_x, B_w1, B_w3, B_w2):
    def _A_ref(x, wqkv, wo):
        B, S, D = x.shape
        H = 32; Dh = D // H
        W, dil = 8, 2
        qkv = (lambda x, *d: x.permute(*d))((x @ wqkv).reshape(B, S, 3, H, Dh), 2, 0, 3, 1, 4)
        q, k, v = qkv[0], qkv[1], qkv[2]
        scale = Dh ** -0.5
        pos = torch.arange(S)
        off = torch.arange(W) * dil
        idx = pos[:, None] - off[None, :]
        mask = idx >= 0
        idx_c = torch.where(mask, idx, 0).reshape(-1)
        kg = k[:, :, idx_c, :].reshape(B, H, S, W, Dh)
        vg = v[:, :, idx_c, :].reshape(B, H, S, W, Dh)
        logits = torch.einsum("bhsd,bhswd->bhsw", q, kg) * scale
        logits = torch.where(mask[None, None, :, :], logits, -1e9)
        attn = _softmax(logits, axis=-1)
        o = torch.einsum("bhsw,bhswd->bhsd", attn, vg)
        return (lambda x, *d: x.permute(*d))(o, 0, 2, 1, 3).reshape(B, S, D) @ wo

    def _B_ref(x, w1, w3, w2):
        gate = torch.einsum("bsd,df->bsf", x, w1)
        up = torch.einsum("bsd,df->bsf", x, w3)
        h = _silu(gate) * up
        out = torch.einsum("bsf,fd->bsd", h, w2)
        return out

    x = A_x
    h = x + _A_ref(_layernorm(x, axis=-1), A_wqkv, A_wo)
    h2 = h + _B_ref(_layernorm(h, axis=-1), B_w1, B_w3, B_w2)
    return h2
```

```asm
; @launch grid=(256,1,1) block=(256,1,1) lds=163840
.amdgcn_target "amdgcn-amd-amdhsa--gfx950"
.text
.globl sequential_preLN__sliding_local_dilated__glu_gated_swiglu__prompt_kernel
.p2align 8
.type sequential_preLN__sliding_local_dilated__glu_gated_swiglu__prompt_kernel,@function
sequential_preLN__sliding_local_dilated__glu_gated_swiglu__prompt_kernel:
    s_cmp_ge_u32 s2, 256
    s_cbranch_scc1 L_done
    s_load_dwordx2 s[12:13], s[0:1], 8
    s_load_dwordx2 s[8:9], s[0:1], 0
    s_load_dwordx2 s[100:101], s[0:1], 64
    s_load_dwordx2 s[36:37], s[0:1], 72
    s_load_dwordx2 s[16:17], s[0:1], 16
    s_load_dwordx8 s[92:99], s[0:1], 32
    v_lshrrev_b32 v2, 6, v0
    v_and_b32 v1, 63, v0
    s_and_b32 s43, s2, 7
    v_readfirstlane_b32 s42, v2
    s_lshr_b32 s50, s2, 3
    s_lshr_b32 s49, s50, 4
    s_lshl_b32 s45, s43, 1
    s_add_u32 s45, s45, s49
    s_and_b32 s46, s50, 15
    s_lshl_b32 s4, s50, 2
    s_add_u32 s4, s4, s42
    s_lshr_b32 s41, s46, 3
    s_lshl_b32 s47, s45, 1
    s_add_u32 s47, s47, s41
    s_and_b32 s48, s46, 7
    s_xor_b32 s40, s48, 4
    s_getpc_b64 s[6:7]
L_pc:
    v_lshlrev_b32 v2, 7, v1
    s_lshl_b32 s49, s4, 8
    v_add_u32 v4, s49, v2
    v_min_u32 v4, L_codeend-L_pc-4, v4
    s_mov_b64 exec, 3
    global_load_dword v3, v4, s[6:7]
    s_mov_b64 exec, -1
    s_memrealtime s[6:7]
    v_lshrrev_b32 v214, 3, v1
    v_bfe_u32 v215, v1, 4, 1
    s_and_b32 s49, s42, 1
    s_lshl_b32 s49, s49, 1
    v_or_b32 v215, s49, v215
    v_lshlrev_b32 v215, 1, v215
    v_and_b32 v216, 7, v1
    v_xor_b32 v215, v215, v216
    s_lshl_b32 s49, s42, 3
    v_add_u32 v214, s49, v214
    v_mul_u32_u24 v214, 3072, v214
    v_lshl_add_u32 v214, v215, 4, v214
    s_lshl_b32 s49, s48, 7
    v_add_u32 v9, s49, v214
    s_lshl_b32 s68, s42, 10
    s_mul_i32 s69, s42, 3072
    v_lshrrev_b32 v212, 4, v0
    v_and_b32 v213, 15, v1
    v_xor_b32 v213, v213, v212
    v_lshlrev_b32 v213, 4, v213
    s_lshl_b32 s50, s47, 16
    v_add_u32 v213, s50, v213
    v_lshl_add_u32 v5, v212, 11, v213
    s_lshr_b32 s49, s42, 1
    s_mul_i32 s49, s49, 17408
    s_add_u32 s49, s49, 15360
    v_subrev_u32 v4, s49, v5
    v_lshlrev_b32 v227, 4, v1
    v_min_u32 v177, 9, v212
    s_mul_i32 s49, s48, 10
    v_add_u32 v177, s49, v177
    s_sub_u32 s49, s50, 16384
    v_and_b32 v214, 0xf0, v227
    v_lshl_add_u32 v214, v177, 10, v214
    v_add_u32 v176, s49, v214
    s_cmp_eq_u32 s42, 0
    s_cselect_b32 s66, 0xffff0000, -1
    s_mov_b32 s67, -1
    s_mov_b32 s49, s43
    s_and_b32 s49, s49, 3
    s_lshr_b32 s51, s43, 2
    s_mul_i32 s65, s51, 196608
    s_add_u32 s50, s49, 0
    s_and_b32 s50, s50, 3
    s_lshl_b32 s57, s50, 8
    s_mul_i32 s61, s50, 393216
    s_add_u32 s50, s49, 1
    s_and_b32 s50, s50, 3
    s_lshl_b32 s58, s50, 8
    s_mul_i32 s62, s50, 393216
    s_add_u32 s50, s49, 2
    s_and_b32 s50, s50, 3
    s_lshl_b32 s59, s50, 8
    s_mul_i32 s63, s50, 393216
    s_add_u32 s50, s49, 3
    s_and_b32 s50, s50, 3
    s_lshl_b32 s60, s50, 8
    s_mul_i32 s64, s50, 393216
    s_lshr_b32 s49, s2, 6
    s_mul_i32 s49, s49, 7
    s_add_u32 s49, s49, s48
    s_cmp_gt_u32 s48, 3
    s_subb_u32 s49, s49, 0
    s_lshl_b32 s49, s49, 2
    s_add_u32 s49, s49, s42
    s_mul_i32 s70, s49, 14336
    s_cmp_eq_u32 s48, 3
    s_cselect_b32 s70, 0x40000000, s70
    v_lshlrev_b32 v219, 10, v1
    s_mov_b32 s14, 1572864
    s_mov_b32 s15, 0x20000
    s_mov_b32 s10, 2097152
    s_mov_b32 s11, 0x20000
    s_mov_b32 s38, 1048576
    s_mov_b32 s39, 0x20000
    s_mov_b32 s18, 524288
    s_mov_b32 s19, 0x20000
    s_waitcnt lgkmcnt(0)
    s_and_b32 s13, s13, 0xffff
    s_and_b32 s9, s9, 0xffff
    s_mov_b32 s52, s70
    s_mov_b64 exec, 0x3fff
    buffer_load_dword v3, v219, s[12:15], s52 offen offset:384
    s_mov_b64 exec, -1
    s_add_u32 s49, 0, s65
    s_add_u32 m0, s69, 61440
    s_add_u32 s49, s49, s61
    buffer_load_dwordx4 v9, s[12:15], s49 offen offset:0 lds
    buffer_load_dwordx4 v9, s[12:15], s49 offen offset:1024 lds
    buffer_load_dwordx4 v9, s[12:15], s49 offen offset:2048 lds
    s_add_u32 m0, s68, 0
    s_mov_b64 exec, s[66:67]
    buffer_load_dwordx4 v4, s[8:11], s57 offen nt lds
    s_mov_b64 exec, -1
    s_add_u32 m0, s68, 4096
    s_add_u32 s50, s57, 0
    buffer_load_dwordx4 v5, s[8:11], s50 offen nt lds
    s_add_u32 m0, s68, 8192
    s_add_u32 s50, s57, 32768
    buffer_load_dwordx4 v5, s[8:11], s50 offen nt lds
    s_add_u32 m0, s68, 12288
    s_add_u32 s50, s57, 1024
    buffer_load_dwordx4 v5, s[8:11], s50 offen nt lds
    s_add_u32 m0, s68, 16384
    s_add_u32 s50, s57, 33792
    buffer_load_dwordx4 v5, s[8:11], s50 offen nt lds
    s_lshl_b32 s49, s45, 2
    v_mov_b32 v210, s49
    s_or_b32 s50, s46, s42
    s_cmp_lg_u32 s50, 0
    s_cbranch_scc1 L_nolead_1
    s_or_b32 s50, s6, 1
    v_mov_b32 v218, s50
    s_mov_b64 exec, 1
    global_store_dword v210, v218, s[100:101] sc1
    s_mov_b64 exec, -1
L_nolead_1:
    s_lshl_b32 s49, s45, 20
    s_add_u32 s36, s36, s49
    s_addc_u32 s37, s37, 0
    s_and_b32 s37, s37, 0xffff
    s_and_b32 s17, s17, 0xffff
    s_mov_b32 s20, s92
    s_and_b32 s21, s93, 0xffff
    s_mov_b32 s22, 1835008
    s_mov_b32 s23, 0x20000
    s_mov_b32 s24, s94
    s_and_b32 s25, s95, 0xffff
    s_mov_b32 s26, 1835008
    s_mov_b32 s27, 0x20000
    s_mov_b32 s28, s96
    s_and_b32 s29, s97, 0xffff
    s_mov_b32 s30, 1835008
    s_mov_b32 s31, 0x20000
    s_mov_b32 s32, s98
    s_and_b32 s33, s99, 0xffff
    s_mov_b32 s34, 2097152
    s_mov_b32 s35, 0x20000
    s_mov_b32 s56, 0x3f803f80
    s_mov_b32 s71, 0
    s_add_u32 s71, s71, 786432
    s_lshl_b32 s49, s46, 4
    s_lshl_b32 s50, s42, 2
    s_add_u32 s5, s49, s50
    s_add_u32 s5, s5, s71
    v_lshlrev_b32 v239, 2, v1
    v_lshrrev_b32 v212, 4, v1
    v_and_b32 v213, 15, v1
    v_xor_b32 v214, v212, v213
    s_lshr_b32 s51, s43, 2
    s_lshl_b32 s51, s51, 3
    v_xor_b32 v214, s51, v214
    v_lshlrev_b32 v215, 8, v213
    v_xor_b32 v216, 0, v214
    v_lshl_add_u32 v10, v216, 4, v215
    v_xor_b32 v216, 4, v214
    v_lshl_add_u32 v11, v216, 4, v215
    v_xor_b32 v216, 8, v214
    v_lshl_add_u32 v12, v216, 4, v215
    v_xor_b32 v216, 12, v214
    v_lshl_add_u32 v13, v216, 4, v215
    v_mul_u32_u24 v214, 3072, v212
    v_bfe_u32 v215, v1, 2, 2
    v_lshl_add_u32 v214, v215, 7, v214
    v_bfe_u32 v215, v1, 3, 2
    v_xor_b32 v215, s42, v215
    v_lshl_add_u32 v214, v215, 5, v214
    v_and_b32 v215, 3, v1
    v_lshl_add_u32 v214, v215, 3, v214
    v_add_u32 v14, 61440, v214
    v_add_u32 v15, 110592, v214
    v_mov_b32 v216, s56
    v_mov_b32 v217, s56
    v_mov_b32 v218, s56
    v_mov_b32 v219, s56
    v_mov_b32 v222, s56
    v_mov_b32 v223, s56
    v_min_u32 v214, 2, v212
    v_mul_u32_u24 v214, 20480, v214
    v_lshl_add_u32 v214, v213, 4, v214
    s_cmp_lg_u32 s42, 0
    s_cbranch_scc1 L_noones_3
    ds_write_b128 v214, v[216:219] offset:0
L_noones_3:
    v_lshlrev_b32 v220, 3, v213
    v_lshlrev_b32 v221, 5, v212
    v_lshrrev_b32 v184, 4, v1
    v_and_b32 v185, 15, v1
    v_lshlrev_b32 v186, 2, v184
    v_sub_u32 v187, v186, v185
    s_cmp_eq_u32 s47, 0
    s_cselect_b32 s0, 0xf149f2ca, 0
    s_mov_b32 s1, 0xf149f2ca
    v_mov_b32 v189, s1
    v_mov_b32 v190, s0
    v_mov_b32 v32, 0
    v_mov_b32 v33, 0
    v_add_u32 v188, 7, v187
    v_cmp_gt_u32 vcc, 8, v188
    v_mov_b32 v191, 0xffff
    s_nop 0
    v_cndmask_b32 v16, v189, 0, vcc
    v_cndmask_b32 v191, 0, v191, vcc
    v_or_b32 v32, v32, v191
    v_add_u32 v188, 0, v187
    v_cmp_lt_i32 vcc, 8, v188
    s_nop 1
    v_cndmask_b32 v20, v189, 0, vcc
    v_cndmask_b32 v24, v189, v190, vcc
    v_cmp_lt_i32 vcc, 0, v188
    v_cmp_gt_u32 s[6:7], 2, v184
    s_and_b64 vcc, vcc, s[6:7]
    s_nop 1
    v_cndmask_b32 v28, v189, v190, vcc
    v_add_u32 v188, 8, v187
    v_cmp_gt_u32 vcc, 8, v188
    v_mov_b32 v191, 0xffff0000
    s_nop 0
    v_cndmask_b32 v17, v189, 0, vcc
    v_cndmask_b32 v191, 0, v191, vcc
    v_or_b32 v32, v32, v191
    v_add_u32 v188, 1, v187
    v_cmp_lt_i32 vcc, 8, v188
    s_nop 1
    v_cndmask_b32 v21, v189, 0, vcc
    v_cndmask_b32 v25, v189, v190, vcc
    v_cmp_lt_i32 vcc, 0, v188
    v_cmp_gt_u32 s[6:7], 2, v184
    s_and_b64 vcc, vcc, s[6:7]
    s_nop 1
    v_cndmask_b32 v29, v189, v190, vcc
    v_add_u32 v188, 9, v187
    v_cmp_gt_u32 vcc, 8, v188
    v_mov_b32 v191, 0xffff
    s_nop 0
    v_cndmask_b32 v18, v189, 0, vcc
    v_cndmask_b32 v191, 0, v191, vcc
    v_or_b32 v33, v33, v191
    v_add_u32 v188, 2, v187
    v_cmp_lt_i32 vcc, 8, v188
    s_nop 1
    v_cndmask_b32 v22, v189, 0, vcc
    v_cndmask_b32 v26, v189, v190, vcc
    v_cmp_lt_i32 vcc, 0, v188
    v_cmp_gt_u32 s[6:7], 2, v184
    s_and_b64 vcc, vcc, s[6:7]
    s_nop 1
    v_cndmask_b32 v30, v189, v190, vcc
    v_add_u32 v188, 10, v187
    v_cmp_gt_u32 vcc, 8, v188
    v_mov_b32 v191, 0xffff0000
    s_nop 0
    v_cndmask_b32 v19, v189, 0, vcc
    v_cndmask_b32 v191, 0, v191, vcc
    v_or_b32 v33, v33, v191
    v_add_u32 v188, 3, v187
    v_cmp_lt_i32 vcc, 8, v188
    s_nop 1
    v_cndmask_b32 v23, v189, 0, vcc
    v_cndmask_b32 v27, v189, v190, vcc
    v_cmp_lt_i32 vcc, 0, v188
    v_cmp_gt_u32 s[6:7], 2, v184
    s_and_b64 vcc, vcc, s[6:7]
    s_nop 1
    v_cndmask_b32 v31, v189, v190, vcc
    v_not_b32 v34, v32
    v_not_b32 v35, v33
    s_lshl_b32 s0, s41, 16
    s_lshl_b32 s1, s48, 12
    s_add_u32 s0, s0, s1
    s_lshl_b32 s1, s42, 10
    s_add_u32 s0, s0, s1
    s_add_u32 s0, s0, 0
    v_lshrrev_b32 v186, 5, v1
    v_lshlrev_b32 v186, 9, v186
    v_lshl_add_u32 v186, v185, 5, v186
    v_and_b32 v187, 1, v184
    v_lshl_add_u32 v186, v187, 4, v186
    v_add_u32 v238, s0, v186
    v_lshrrev_b32 v186, 3, v1
    v_lshlrev_b32 v186, 10, v186
    v_bfe_u32 v187, v1, 4, 1
    v_lshlrev_b32 v187, 2, v187
    v_and_b32 v188, 7, v1
    v_xor_b32 v187, v187, v188
    v_lshl_add_u32 v186, v187, 4, v186
    s_lshl_b32 s0, s40, 7
    v_add_u32 v226, s0, v186
    v_lshrrev_b32 v186, 2, v1
    v_mul_u32_u24 v186, 3584, v186
    v_and_b32 v187, 3, v1
    v_lshl_add_u32 v186, v187, 4, v186
    s_lshl_b32 s0, s46, 8
    s_lshl_b32 s1, s42, 6
    s_add_u32 s0, s0, s1
    s_cmp_lt_u32 s46, 14
    s_cselect_b32 s0, s0, 0x40000000
    v_add_u32 v233, s0, v186
    v_bfe_u32 v187, v1, 4, 1
    v_lshlrev_b32 v186, 5, v187
    v_and_b32 v187, 1, v1
    v_lshl_add_u32 v186, v187, 4, v186
    v_bfe_u32 v187, v1, 1, 1
    v_lshl_add_u32 v186, v187, 3, v186
    v_lshrrev_b32 v188, 5, v1
    v_lshlrev_b32 v188, 3, v188
    v_bfe_u32 v187, v1, 2, 2
    v_add_u32 v188, v188, v187
    v_lshl_add_u32 v189, v188, 7, v186
    v_lshl_add_u32 v190, v188, 6, v186
    v_bfe_u32 v187, v1, 3, 1
    s_lshr_b32 s0, s42, 1
    v_xor_b32 v187, s0, v187
    v_lshl_add_u32 v224, v187, 6, v189
    v_xor_b32 v225, 64, v224
    s_lshl_b32 s0, s42, 10
    s_add_u32 s0, s0, 159744
    v_add_u32 v234, s0, v190
    v_add_u32 v235, s0, v227
    v_add_u32 v236, 65536, v227
    v_lshrrev_b32 v186, 3, v1
    v_lshlrev_b32 v186, 10, v186
    v_bfe_u32 v187, v1, 4, 1
    v_lshlrev_b32 v187, 1, v187
    v_and_b32 v188, 7, v1
    v_xor_b32 v187, v187, v188
    v_lshl_add_u32 v186, v187, 4, v186
    s_lshl_b32 s0, s40, 7
    v_add_u32 v228, s0, v186
    v_xor_b32 v229, 64, v228
    v_lshlrev_b32 v186, 10, v184
    v_bfe_u32 v187, v1, 2, 2
    v_lshl_add_u32 v186, v187, 7, v186
    v_bfe_u32 v187, v1, 3, 2
    v_lshl_add_u32 v186, v187, 5, v186
    v_and_b32 v187, 3, v1
    v_lshl_add_u32 v186, v187, 3, v186
    v_add_u32 v230, 45056, v186
    s_and_b32 s0, s42, 1
    s_lshl_b32 s0, s0, 8
    v_lshlrev_b32 v186, 4, v185
    v_add_u32 v186, s0, v186
    v_lshl_add_u32 v237, v184, 9, v186
    v_and_b32 v187, 1, v184
    v_lshl_add_u32 v186, v187, 10, v186
    v_lshrrev_b32 v187, 1, v184
    v_lshl_add_u32 v231, v187, 9, v186
    s_lshl_b32 s0, s47, 16
    s_lshl_b32 s1, s42, 14
    s_add_u32 s0, s0, s1
    s_lshl_b32 s1, s40, 7
    s_add_u32 s0, s0, s1
    v_lshlrev_b32 v186, 10, v185
    v_lshl_add_u32 v186, v184, 3, v186
    v_add_u32 v232, s0, v186
    v_lshrrev_b32 v178, 1, v177
    v_and_b32 v179, 1, v177
    v_lshl_add_u32 v180, v179, 5, v178
    v_add_u32 v180, 8, v180
    v_xor_b32 v179, 1, v179
    v_lshl_add_u32 v178, v179, 3, v178
    v_cmp_gt_u32 vcc, 16, v177
    s_nop 1
    v_cndmask_b32 v177, v180, v178, vcc
    v_lshlrev_b32 v177, 3, v177
    s_add_u32 s49, 98304, s65
    s_add_u32 m0, s69, 73728
    s_add_u32 s49, s49, s61
    buffer_load_dwordx4 v9, s[12:15], s49 offen offset:0 lds
    buffer_load_dwordx4 v9, s[12:15], s49 offen offset:1024 lds
    buffer_load_dwordx4 v9, s[12:15], s49 offen offset:2048 lds
    buffer_load_dwordx4 v[160:163], v176, s[8:11], 0 offen offset:0 nt
    buffer_load_dwordx4 v[164:167], v176, s[8:11], 0 offen offset:256 nt
    buffer_load_dwordx4 v[168:171], v176, s[8:11], 0 offen offset:512 nt
    buffer_load_dwordx4 v[172:175], v176, s[8:11], 0 offen offset:768 nt
    s_sub_u32 s49, 196608, s65
    s_add_u32 m0, s69, 86016
    s_add_u32 s49, s49, s61
    buffer_load_dwordx4 v9, s[12:15], s49 offen offset:0 lds
    buffer_load_dwordx4 v9, s[12:15], s49 offen offset:1024 lds
    buffer_load_dwordx4 v9, s[12:15], s49 offen offset:2048 lds
    s_sub_u32 s49, 294912, s65
    s_add_u32 m0, s69, 98304
    s_add_u32 s49, s49, s61
    buffer_load_dwordx4 v9, s[12:15], s49 offen offset:0 lds
    buffer_load_dwordx4 v9, s[12:15], s49 offen offset:1024 lds
    buffer_load_dwordx4 v9, s[12:15], s49 offen offset:2048 lds
    s_waitcnt vmcnt(10)
    s_waitcnt lgkmcnt(0)
    s_barrier
    ds_read_b64_tr_b16 v[96:97], v14 offset:0
    ds_read_b64_tr_b16 v[98:99], v14 offset:512
    ds_read_b64_tr_b16 v[100:101], v14 offset:1024
    ds_read_b64_tr_b16 v[102:103], v14 offset:1536
    ds_read_b64_tr_b16 v[104:105], v14 offset:2048
    ds_read_b64_tr_b16 v[106:107], v14 offset:2560
    ds_read_b128 v[120:123], v10 offset:0
    ds_read_b128 v[124:127], v10 offset:4096
    ds_read_b128 v[128:131], v10 offset:8192
    ds_read_b128 v[132:135], v10 offset:12288
    ds_read_b128 v[136:139], v10 offset:16384
    s_waitcnt lgkmcnt(0)
    v_mfma_f32_16x16x32_bf16 v[36:39], v[96:99], v[120:123], 0
    ds_read_b64_tr_b16 v[108:109], v14 offset:12288
    s_add_u32 s49, 0, s65
    s_add_u32 m0, s69, 110592
    s_add_u32 s49, s49, s62
    buffer_load_dwordx4 v9, s[12:15], s49 offen offset:0 lds
    v_mfma_f32_16x16x32_bf16 v[56:59], v[100:103], v[120:123], 0
    ds_read_b64_tr_b16 v[110:111], v14 offset:12800
    buffer_load_dwordx4 v9, s[12:15], s49 offen offset:1024 lds
    v_mfma_f32_16x16x32_bf16 v[76:79], v[120:123], v[104:107], 0
    ds_read_b64_tr_b16 v[112:113], v14 offset:13312
    buffer_load_dwordx4 v9, s[12:15], s49 offen offset:2048 lds
    v_mfma_f32_16x16x32_bf16 v[40:43], v[96:99], v[124:127], 0
    ds_read_b64_tr_b16 v[114:115], v14 offset:13824
    s_add_u32 s49, 98304, s65
    s_add_u32 m0, s69, 122880
    s_add_u32 s49, s49, s62
    buffer_load_dwordx4 v9, s[12:15], s49 offen offset:0 lds
    v_mfma_f32_16x16x32_bf16 v[60:63], v[100:103], v[124:127], 0
    ds_read_b64_tr_b16 v[116:117], v14 offset:14336
    buffer_load_dwordx4 v9, s[12:15], s49 offen offset:1024 lds
    v_mfma_f32_16x16x32_bf16 v[80:83], v[124:127], v[104:107], 0
    ds_read_b64_tr_b16 v[118:119], v14 offset:14848
    buffer_load_dwordx4 v9, s[12:15], s49 offen offset:2048 lds
    v_mfma_f32_16x16x32_bf16 v[44:47], v[96:99], v[128:131], 0
    ds_read_b128 v[140:143], v11 offset:0
    s_add_u32 m0, s68, 20480
    s_mov_b64 exec, s[66:67]
    buffer_load_dwordx4 v4, s[8:11], s58 offen nt lds
    s_mov_b64 exec, -1
    v_mfma_f32_16x16x32_bf16 v[64:67], v[100:103], v[128:131], 0
    ds_read_b128 v[144:147], v11 offset:4096
    s_add_u32 m0, s68, 24576
    s_add_u32 s50, s58, 0
    buffer_load_dwordx4 v5, s[8:11], s50 offen nt lds
    v_mfma_f32_16x16x32_bf16 v[84:87], v[128:131], v[104:107], 0
    ds_read_b128 v[148:151], v11 offset:8192
    s_add_u32 m0, s68, 28672
    s_add_u32 s50, s58, 32768
    buffer_load_dwordx4 v5, s[8:11], s50 offen nt lds
    v_mfma_f32_16x16x32_bf16 v[48:51], v[96:99], v[132:135], 0
    ds_read_b128 v[152:155], v11 offset:12288
    s_add_u32 m0, s68, 32768
    s_add_u32 s50, s58, 1024
    buffer_load_dwordx4 v5, s[8:11], s50 offen nt lds
    v_mfma_f32_16x16x32_bf16 v[68:71], v[100:103], v[132:135], 0
    ds_read_b128 v[156:159], v11 offset:16384
    s_add_u32 m0, s68, 36864
    s_add_u32 s50, s58, 33792
    buffer_load_dwordx4 v5, s[8:11], s50 offen nt lds
    v_mfma_f32_16x16x32_bf16 v[88:91], v[132:135], v[104:107], 0
    s_sub_u32 s49, 196608, s65
    s_add_u32 m0, s69, 135168
    s_add_u32 s49, s49, s62
    buffer_load_dwordx4 v9, s[12:15], s49 offen offset:0 lds
    v_mfma_f32_16x16x32_bf16 v[52:55], v[96:99], v[136:139], 0
    v_mfma_f32_16x16x32_bf16 v[72:75], v[100:103], v[136:139], 0
    buffer_load_dwordx4 v9, s[12:15], s49 offen offset:1024 lds
    v_mfma_f32_16x16x32_bf16 v[92:95], v[136:139], v[104:107], 0
    s_waitcnt vmcnt(19)
    v_dot2_f32_bf16 v178, v160, s56, 0
    v_dot2_f32_bf16 v179, v160, v160, 0
    v_dot2_f32_bf16 v180, v161, s56, 0
    v_dot2_f32_bf16 v181, v161, v161, 0
    v_dot2c_f32_bf16 v178, s56, v162
    v_dot2c_f32_bf16 v179, v162, v162
    v_dot2c_f32_bf16 v180, s56, v163
    v_dot2c_f32_bf16 v181, v163, v163
    v_dot2c_f32_bf16 v178, s56, v164
    v_dot2c_f32_bf16 v179, v164, v164
    v_dot2c_f32_bf16 v180, s56, v165
    v_dot2c_f32_bf16 v181, v165, v165
    v_dot2c_f32_bf16 v178, s56, v166
    v_dot2c_f32_bf16 v179, v166, v166
    v_dot2c_f32_bf16 v180, s56, v167
    v_dot2c_f32_bf16 v181, v167, v167
    v_dot2c_f32_bf16 v178, s56, v168
    v_dot2c_f32_bf16 v179, v168, v168
    v_dot2c_f32_bf16 v180, s56, v169
    v_dot2c_f32_bf16 v181, v169, v169
    v_dot2c_f32_bf16 v178, s56, v170
    v_dot2c_f32_bf16 v179, v170, v170
    v_dot2c_f32_bf16 v180, s56, v171
    v_dot2c_f32_bf16 v181, v171, v171
    v_dot2c_f32_bf16 v178, s56, v172
    v_dot2c_f32_bf16 v179, v172, v172
    v_dot2c_f32_bf16 v180, s56, v173
    v_dot2c_f32_bf16 v181, v173, v173
    v_dot2c_f32_bf16 v178, s56, v174
    v_dot2c_f32_bf16 v179, v174, v174
    v_dot2c_f32_bf16 v180, s56, v175
    v_dot2c_f32_bf16 v181, v175, v175
    s_lshl_b32 s51, s41, 10
    s_add_u32 s51, s51, 753664
    s_nop 0
    v_pk_add_f32 v[178:179], v[178:179], v[180:181]
    s_nop 1
    v_add_f32_dpp v178, v178, v178 row_ror:8 row_mask:0xf bank_mask:0xf
    v_add_f32_dpp v179, v179, v179 row_ror:8 row_mask:0xf bank_mask:0xf
    s_nop 0
    v_add_f32_dpp v178, v178, v178 row_ror:4 row_mask:0xf bank_mask:0xf
    v_add_f32_dpp v179, v179, v179 row_ror:4 row_mask:0xf bank_mask:0xf
    s_nop 0
    v_add_f32_dpp v178, v178, v178 row_ror:2 row_mask:0xf bank_mask:0xf
    v_add_f32_dpp v179, v179, v179 row_ror:2 row_mask:0xf bank_mask:0xf
    s_nop 0
    v_add_f32_dpp v178, v178, v178 row_ror:1 row_mask:0xf bank_mask:0xf
    v_add_f32_dpp v179, v179, v179 row_ror:1 row_mask:0xf bank_mask:0xf
    s_nop 0
    v_mul_f32 v180, 0xbb000000, v178
    v_mul_f32 v181, 0x3b000000, v179
    v_fma_f32 v181, -v180, v180, v181
    v_max_f32 v181, 0, v181
    v_add_f32 v181, 0x3727c5ac, v181
    v_rsq_f32 v181, v181
    s_mov_b32 exec_lo, 0x00010001
    s_mov_b32 exec_hi, 0x00010001
    buffer_store_dwordx2 v[180:181], v177, s[36:39], s51 offen sc1
    s_mov_b64 exec, -1
    global_load_dword v211, v210, s[100:101] sc1
    s_waitcnt lgkmcnt(0)
    s_waitcnt vmcnt(15)
    s_barrier
    v_mfma_f32_16x16x32_bf16 v[36:39], v[108:111], v[140:143], v[36:39]
    ds_read_b64_tr_b16 v[96:97], v14 offset:24576
    v_mfma_f32_16x16x32_bf16 v[56:59], v[112:115], v[140:143], v[56:59]
    ds_read_b64_tr_b16 v[98:99], v14 offset:25088
    buffer_load_dwordx4 v9, s[12:15], s49 offen offset:2048 lds
    v_mfma_f32_16x16x32_bf16 v[76:79], v[140:143], v[116:119], v[76:79]
    ds_read_b64_tr_b16 v[100:101], v14 offset:25600
    v_mfma_f32_16x16x32_bf16 v[40:43], v[108:111], v[144:147], v[40:43]
    ds_read_b64_tr_b16 v[102:103], v14 offset:26112
    v_mfma_f32_16x16x32_bf16 v[60:63], v[112:115], v[144:147], v[60:63]
    ds_read_b64_tr_b16 v[104:105], v14 offset:26624
    s_sub_u32 s49, 294912, s65
    s_add_u32 m0, s69, 147456
    s_add_u32 s49, s49, s62
    buffer_load_dwordx4 v9, s[12:15], s49 offen offset:0 lds
    v_mfma_f32_16x16x32_bf16 v[80:83], v[144:147], v[116:119], v[80:83]
    ds_read_b64_tr_b16 v[106:107], v14 offset:27136
    v_mfma_f32_16x16x32_bf16 v[44:47], v[108:111], v[148:151], v[44:47]
    ds_read_b128 v[120:123], v12 offset:0
    v_mfma_f32_16x16x32_bf16 v[64:67], v[112:115], v[148:151], v[64:67]
    ds_read_b128 v[124:127], v12 offset:4096
    buffer_load_dwordx4 v9, s[12:15], s49 offen offset:1024 lds
    v_mfma_f32_16x16x32_bf16 v[84:87], v[148:151], v[116:119], v[84:87]
    ds_read_b128 v[128:131], v12 offset:8192
    v_mfma_f32_16x16x32_bf16 v[48:51], v[108:111], v[152:155], v[48:51]
    ds_read_b128 v[132:135], v12 offset:12288
    v_mfma_f32_16x16x32_bf16 v[68:71], v[112:115], v[152:155], v[68:71]
    ds_read_b128 v[136:139], v12 offset:16384
    buffer_load_dwordx4 v9, s[12:15], s49 offen offset:2048 lds
    v_mfma_f32_16x16x32_bf16 v[88:91], v[152:155], v[116:119], v[88:91]
    v_mfma_f32_16x16x32_bf16 v[52:55], v[108:111], v[156:159], v[52:55]
    v_mfma_f32_16x16x32_bf16 v[72:75], v[112:115], v[156:159], v[72:75]
    s_add_u32 m0, s68, 40960
    s_mov_b64 exec, s[66:67]
    buffer_load_dwordx4 v4, s[8:11], s59 offen nt lds
    s_mov_b64 exec, -1
    v_mfma_f32_16x16x32_bf16 v[92:95], v[156:159], v[116:119], v[92:95]
    s_waitcnt lgkmcnt(0)
    v_mfma_f32_16x16x32_bf16 v[36:39], v[96:99], v[120:123], v[36:39]
    ds_read_b64_tr_b16 v[108:109], v14 offset:36864
    v_mfma_f32_16x16x32_bf16 v[56:59], v[100:103], v[120:123], v[56:59]
    ds_read_b64_tr_b16 v[110:111], v14 offset:37376
    s_add_u32 m0, s68, 45056
    s_add_u32 s50, s59, 0
    buffer_load_dwordx4 v5, s[8:11], s50 offen nt lds
    v_mfma_f32_16x16x32_bf16 v[76:79], v[120:123], v[104:107], v[76:79]
    ds_read_b64_tr_b16 v[112:113], v14 offset:37888
    v_mfma_f32_16x16x32_bf16 v[40:43], v[96:99], v[124:127], v[40:43]
    ds_read_b64_tr_b16 v[114:115], v14 offset:38400
    v_mfma_f32_16x16x32_bf16 v[60:63], v[100:103], v[124:127], v[60:63]
    ds_read_b64_tr_b16 v[116:117], v14 offset:38912
    s_add_u32 m0, s68, 49152
    s_add_u32 s50, s59, 32768
    buffer_load_dwordx4 v5, s[8:11], s50 offen nt lds
    v_mfma_f32_16x16x32_bf16 v[80:83], v[124:127], v[104:107], v[80:83]
    ds_read_b64_tr_b16 v[118:119], v14 offset:39424
    v_mfma_f32_16x16x32_bf16 v[44:47], v[96:99], v[128:131], v[44:47]
    ds_read_b128 v[140:143], v13 offset:0
    v_mfma_f32_16x16x32_bf16 v[64:67], v[100:103], v[128:131], v[64:67]
    ds_read_b128 v[144:147], v13 offset:4096
    s_add_u32 m0, s68, 53248
    s_add_u32 s50, s59, 1024
    buffer_load_dwordx4 v5, s[8:11], s50 offen nt lds
    v_mfma_f32_16x16x32_bf16 v[84:87], v[128:131], v[104:107], v[84:87]
    ds_read_b128 v[148:151], v13 offset:8192
    v_mfma_f32_16x16x32_bf16 v[48:51], v[96:99], v[132:135], v[48:51]
    ds_read_b128 v[152:155], v13 offset:12288
    v_mfma_f32_16x16x32_bf16 v[68:71], v[100:103], v[132:135], v[68:71]
    ds_read_b128 v[156:159], v13 offset:16384
    s_add_u32 m0, s68, 57344
    s_add_u32 s50, s59, 33792
    buffer_load_dwordx4 v5, s[8:11], s50 offen nt lds
    v_mfma_f32_16x16x32_bf16 v[88:91], v[132:135], v[104:107], v[88:91]
    v_mfma_f32_16x16x32_bf16 v[52:55], v[96:99], v[136:139], v[52:55]
    v_mfma_f32_16x16x32_bf16 v[72:75], v[100:103], v[136:139], v[72:75]
    s_add_u32 s49, 0, s65
    s_add_u32 m0, s69, 61440
    s_add_u32 s49, s49, s63
    buffer_load_dwordx4 v9, s[12:15], s49 offen offset:0 lds
    v_mfma_f32_16x16x32_bf16 v[92:95], v[136:139], v[104:107], v[92:95]
    s_waitcnt lgkmcnt(0)
    s_waitcnt vmcnt(10)
    v_readfirstlane_b32 s3, v211
    s_mov_b32 s55, 0
    s_cmp_eq_u32 s3, 0
    s_cbranch_scc1 L_nl_4
L_nl_4_ok:
    s_barrier
    s_cmp_lg_u32 s42, 0
    s_cbranch_scc1 L_nostart_5
    s_getreg_b32 s53, hwreg(HW_REG_XCC_ID)
    s_and_b32 s53, s53, 15
    s_lshl_b32 s54, s46, 3
    s_add_u32 s54, s54, s71
    v_mov_b32 v214, 28672
    v_mov_b32 v212, s3
    v_mov_b32 v213, s53
    s_mov_b64 exec, 1
    buffer_store_dwordx2 v[212:213], v214, s[36:39], s54 offen sc1
    s_mov_b64 exec, -1
L_nostart_5:
    v_mfma_f32_16x16x32_bf16 v[36:39], v[108:111], v[140:143], v[36:39]
    ds_read_b64_tr_b16 v[96:97], v15 offset:0
    v_mfma_f32_16x16x32_bf16 v[56:59], v[112:115], v[140:143], v[56:59]
    ds_read_b64_tr_b16 v[98:99], v15 offset:512
    buffer_load_dwordx4 v9, s[12:15], s49 offen offset:1024 lds
    v_mfma_f32_16x16x32_bf16 v[76:79], v[140:143], v[116:119], v[76:79]
    ds_read_b64_tr_b16 v[100:101], v15 offset:1024
    v_mfma_f32_16x16x32_bf16 v[40:43], v[108:111], v[144:147], v[40:43]
    ds_read_b64_tr_b16 v[102:103], v15 offset:1536
    v_mfma_f32_16x16x32_bf16 v[60:63], v[112:115], v[144:147], v[60:63]
    ds_read_b64_tr_b16 v[104:105], v15 offset:2048
    buffer_load_dwordx4 v9, s[12:15], s49 offen offset:2048 lds
    v_mfma_f32_16x16x32_bf16 v[80:83], v[144:147], v[116:119], v[80:83]
    ds_read_b64_tr_b16 v[106:107], v15 offset:2560
    v_mfma_f32_16x16x32_bf16 v[44:47], v[108:111], v[148:151], v[44:47]
    ds_read_b128 v[120:123], v10 offset:20480
    s_add_u32 s49, 98304, s65
    s_add_u32 m0, s69, 73728
    s_add_u32 s49, s49, s63
    buffer_load_dwordx4 v9, s[12:15], s49 offen offset:0 lds
    v_mfma_f32_16x16x32_bf16 v[64:67], v[112:115], v[148:151], v[64:67]
    ds_read_b128 v[124:127], v10 offset:24576
    v_mfma_f32_16x16x32_bf16 v[84:87], v[148:151], v[116:119], v[84:87]
    ds_read_b128 v[128:131], v10 offset:28672
    v_mfma_f32_16x16x32_bf16 v[48:51], v[108:111], v[152:155], v[48:51]
    ds_read_b128 v[132:135], v10 offset:32768
    buffer_load_dwordx4 v9, s[12:15], s49 offen offset:1024 lds
    v_mfma_f32_16x16x32_bf16 v[68:71], v[112:115], v[152:155], v[68:71]
    ds_read_b128 v[136:139], v10 offset:36864
    v_mfma_f32_16x16x32_bf16 v[88:91], v[152:155], v[116:119], v[88:91]
    v_mfma_f32_16x16x32_bf16 v[52:55], v[108:111], v[156:159], v[52:55]
    buffer_load_dwordx4 v9, s[12:15], s49 offen offset:2048 lds
    v_mfma_f32_16x16x32_bf16 v[72:75], v[112:115], v[156:159], v[72:75]
    v_mfma_f32_16x16x32_bf16 v[92:95], v[156:159], v[116:119], v[92:95]
    s_waitcnt lgkmcnt(0)
    v_mfma_f32_16x16x32_bf16 v[36:39], v[96:99], v[120:123], v[36:39]
    ds_read_b64_tr_b16 v[108:109], v15 offset:12288
    s_sub_u32 s49, 196608, s65
    s_add_u32 m0, s69, 86016
    s_add_u32 s49, s49, s63
    buffer_load_dwordx4 v9, s[12:15], s49 offen offset:0 lds
    v_mfma_f32_16x16x32_bf16 v[56:59], v[100:103], v[120:123], v[56:59]
    ds_read_b64_tr_b16 v[110:111], v15 offset:12800
    v_mfma_f32_16x16x32_bf16 v[76:79], v[120:123], v[104:107], v[76:79]
    ds_read_b64_tr_b16 v[112:113], v15 offset:13312
    v_mfma_f32_16x16x32_bf16 v[40:43], v[96:99], v[124:127], v[40:43]
    ds_read_b64_tr_b16 v[114:115], v15 offset:13824
    buffer_load_dwordx4 v9, s[12:15], s49 offen offset:1024 lds
    v_mfma_f32_16x16x32_bf16 v[60:63], v[100:103], v[124:127], v[60:63]
    ds_read_b64_tr_b16 v[116:117], v15 offset:14336
    v_mfma_f32_16x16x32_bf16 v[80:83], v[124:127], v[104:107], v[80:83]
    ds_read_b64_tr_b16 v[118:119], v15 offset:14848
    v_mfma_f32_16x16x32_bf16 v[44:47], v[96:99], v[128:131], v[44:47]
    ds_read_b128 v[140:143], v11 offset:20480
    buffer_load_dwordx4 v9, s[12:15], s49 offen offset:2048 lds
    v_mfma_f32_16x16x32_bf16 v[64:67], v[100:103], v[128:131], v[64:67]
    ds_read_b128 v[144:147], v11 offset:24576
    v_mfma_f32_16x16x32_bf16 v[84:87], v[128:131], v[104:107], v[84:87]
    ds_read_b128 v[148:151], v11 offset:28672
    v_mfma_f32_16x16x32_bf16 v[48:51], v[96:99], v[132:135], v[48:51]
    ds_read_b128 v[152:155], v11 offset:32768
    s_sub_u32 s49, 294912, s65
    s_add_u32 m0, s69, 98304
    s_add_u32 s49, s49, s63
    buffer_load_dwordx4 v9, s[12:15], s49 offen offset:0 lds
    v_mfma_f32_16x16x32_bf16 v[68:71], v[100:103], v[132:135], v[68:71]
    ds_read_b128 v[156:159], v11 offset:36864
    v_mfma_f32_16x16x32_bf16 v[88:91], v[132:135], v[104:107], v[88:91]
    v_mfma_f32_16x16x32_bf16 v[52:55], v[96:99], v[136:139], v[52:55]
    buffer_load_dwordx4 v9, s[12:15], s49 offen offset:1024 lds
    v_mfma_f32_16x16x32_bf16 v[72:75], v[100:103], v[136:139], v[72:75]
    v_mfma_f32_16x16x32_bf16 v[92:95], v[136:139], v[104:107], v[92:95]
    s_waitcnt lgkmcnt(0)
    s_waitcnt vmcnt(16)
    s_barrier
    v_mfma_f32_16x16x32_bf16 v[36:39], v[108:111], v[140:143], v[36:39]
    ds_read_b64_tr_b16 v[96:97], v15 offset:24576
    buffer_load_dwordx4 v9, s[12:15], s49 offen offset:2048 lds
    v_mfma_f32_16x16x32_bf16 v[56:59], v[112:115], v[140:143], v[56:59]
    ds_read_b64_tr_b16 v[98:99], v15 offset:25088
    v_mfma_f32_16x16x32_bf16 v[76:79], v[140:143], v[116:119], v[76:79]
    ds_read_b64_tr_b16 v[100:101], v15 offset:25600
    v_mfma_f32_16x16x32_bf16 v[40:43], v[108:111], v[144:147], v[40:43]
    ds_read_b64_tr_b16 v[102:103], v15 offset:26112
    s_add_u32 m0, s68, 0
    s_mov_b64 exec, s[66:67]
    buffer_load_dwordx4 v4, s[8:11], s60 offen nt lds
    s_mov_b64 exec, -1
    v_mfma_f32_16x16x32_bf16 v[60:63], v[112:115], v[144:147], v[60:63]
    ds_read_b64_tr_b16 v[104:105], v15 offset:26624
    v_mfma_f32_16x16x32_bf16 v[80:83], v[144:147], v[116:119], v[80:83]
    ds_read_b64_tr_b16 v[106:107], v15 offset:27136
    v_mfma_f32_16x16x32_bf16 v[44:47], v[108:111], v[148:151], v[44:47]
    ds_read_b128 v[120:123], v12 offset:20480
    s_add_u32 m0, s68, 4096
    s_add_u32 s50, s60, 0
    buffer_load_dwordx4 v5, s[8:11], s50 offen nt lds
    v_mfma_f32_16x16x32_bf16 v[64:67], v[112:115], v[148:151], v[64:67]
    ds_read_b128 v[124:127], v12 offset:24576
    v_mfma_f32_16x16x32_bf16 v[84:87], v[148:151], v[116:119], v[84:87]
    ds_read_b128 v[128:131], v12 offset:28672
    v_mfma_f32_16x16x32_bf16 v[48:51], v[108:111], v[152:155], v[48:51]
    ds_read_b128 v[132:135], v12 offset:32768
    s_add_u32 m0, s68, 8192
    s_add_u32 s50, s60, 32768
    buffer_load_dwordx4 v5, s[8:11], s50 offen nt lds
    v_mfma_f32_16x16x32_bf16 v[68:71], v[112:115], v[152:155], v[68:71]
    ds_read_b128 v[136:139], v12 offset:36864
    v_mfma_f32_16x16x32_bf16 v[88:91], v[152:155], v[116:119], v[88:91]
    v_mfma_f32_16x16x32_bf16 v[52:55], v[108:111], v[156:159], v[52:55]
    s_add_u32 m0, s68, 12288
    s_add_u32 s50, s60, 1024
    buffer_load_dwordx4 v5, s[8:11], s50 offen nt lds
    v_mfma_f32_16x16x32_bf16 v[72:75], v[112:115], v[156:159], v[72:75]
    v_mfma_f32_16x16x32_bf16 v[92:95], v[156:159], v[116:119], v[92:95]
    s_add_u32 m0, s68, 16384
    s_add_u32 s50, s60, 33792
    buffer_load_dwordx4 v5, s[8:11], s50 offen nt lds
    s_waitcnt lgkmcnt(0)
    v_mfma_f32_16x16x32_bf16 v[36:39], v[96:99], v[120:123], v[36:39]
    ds_read_b64_tr_b16 v[108:109], v15 offset:36864
    v_mfma_f32_16x16x32_bf16 v[56:59], v[100:103], v[120:123], v[56:59]
    ds_read_b64_tr_b16 v[110:111], v15 offset:37376
    v_mfma_f32_16x16x32_bf16 v[76:79], v[120:123], v[104:107], v[76:79]
    ds_read_b64_tr_b16 v[112:113], v15 offset:37888
    s_add_u32 s49, 0, s65
    s_add_u32 m0, s69, 110592
    s_add_u32 s49, s49, s64
    buffer_load_dwordx4 v9, s[12:15], s49 offen offset:0 lds
    v_mfma_f32_16x16x32_bf16 v[40:43], v[96:99], v[124:127], v[40:43]
    ds_read_b64_tr_b16 v[114:115], v15 offset:38400
    v_mfma_f32_16x16x32_bf16 v[60:63], v[100:103], v[124:127], v[60:63]
    ds_read_b64_tr_b16 v[116:117], v15 offset:38912
    v_mfma_f32_16x16x32_bf16 v[80:83], v[124:127], v[104:107], v[80:83]
    ds_read_b64_tr_b16 v[118:119], v15 offset:39424
    buffer_load_dwordx4 v9, s[12:15], s49 offen offset:1024 lds
    v_mfma_f32_16x16x32_bf16 v[44:47], v[96:99], v[128:131], v[44:47]
    ds_read_b128 v[140:143], v13 offset:20480
    v_mfma_f32_16x16x32_bf16 v[64:67], v[100:103], v[128:131], v[64:67]
    ds_read_b128 v[144:147], v13 offset:24576
    v_mfma_f32_16x16x32_bf16 v[84:87], v[128:131], v[104:107], v[84:87]
    ds_read_b128 v[148:151], v13 offset:28672
    buffer_load_dwordx4 v9, s[12:15], s49 offen offset:2048 lds
    v_mfma_f32_16x16x32_bf16 v[48:51], v[96:99], v[132:135], v[48:51]
    ds_read_b128 v[152:155], v13 offset:32768
    v_mfma_f32_16x16x32_bf16 v[68:71], v[100:103], v[132:135], v[68:71]
    ds_read_b128 v[156:159], v13 offset:36864
    v_mfma_f32_16x16x32_bf16 v[88:91], v[132:135], v[104:107], v[88:91]
    s_add_u32 s49, 98304, s65
    s_add_u32 m0, s69, 122880
    s_add_u32 s49, s49, s64
    buffer_load_dwordx4 v9, s[12:15], s49 offen offset:0 lds
    v_mfma_f32_16x16x32_bf16 v[52:55], v[96:99], v[136:139], v[52:55]
    v_mfma_f32_16x16x32_bf16 v[72:75], v[100:103], v[136:139], v[72:75]
    v_mfma_f32_16x16x32_bf16 v[92:95], v[136:139], v[104:107], v[92:95]
    buffer_load_dwordx4 v9, s[12:15], s49 offen offset:1024 lds
    s_waitcnt lgkmcnt(0)
    s_waitcnt vmcnt(16)
    s_barrier
    v_mfma_f32_16x16x32_bf16 v[36:39], v[108:111], v[140:143], v[36:39]
    ds_read_b64_tr_b16 v[96:97], v14 offset:0
    v_mfma_f32_16x16x32_bf16 v[56:59], v[112:115], v[140:143], v[56:59]
    ds_read_b64_tr_b16 v[98:99], v14 offset:512
    s_add_u32 s53, s71, 28672
    buffer_load_dwordx2 v[212:213], v220, s[36:39], s53 offen sc1
    v_mfma_f32_16x16x32_bf16 v[76:79], v[140:143], v[116:119], v[76:79]
    ds_read_b64_tr_b16 v[100:101], v14 offset:1024
    buffer_load_dwordx4 v9, s[12:15], s49 offen offset:2048 lds
    v_mfma_f32_16x16x32_bf16 v[40:43], v[108:111], v[144:147], v[40:43]
    ds_read_b64_tr_b16 v[102:103], v14 offset:1536
    v_mfma_f32_16x16x32_bf16 v[60:63], v[112:115], v[144:147], v[60:63]
    ds_read_b64_tr_b16 v[104:105], v14 offset:2048
    v_mfma_f32_16x16x32_bf16 v[80:83], v[144:147], v[116:119], v[80:83]
    ds_read_b64_tr_b16 v[106:107], v14 offset:2560
    s_sub_u32 s49, 196608, s65
    s_add_u32 m0, s69, 135168
    s_add_u32 s49, s49, s64
    buffer_load_dwordx4 v9, s[12:15], s49 offen offset:0 lds
    v_mfma_f32_16x16x32_bf16 v[44:47], v[108:111], v[148:151], v[44:47]
    ds_read_b128 v[120:123], v10 offset:40960
    v_mfma_f32_16x16x32_bf16 v[64:67], v[112:115], v[148:151], v[64:67]
    ds_read_b128 v[124:127], v10 offset:45056
    v_mfma_f32_16x16x32_bf16 v[84:87], v[148:151], v[116:119], v[84:87]
    ds_read_b128 v[128:131], v10 offset:49152
    buffer_load_dwordx4 v9, s[12:15], s49 offen offset:1024 lds
    v_mfma_f32_16x16x32_bf16 v[48:51], v[108:111], v[152:155], v[48:51]
    ds_read_b128 v[132:135], v10 offset:53248
    v_mfma_f32_16x16x32_bf16 v[68:71], v[112:115], v[152:155], v[68:71]
    ds_read_b128 v[136:139], v10 offset:57344
    v_mfma_f32_16x16x32_bf16 v[88:91], v[152:155], v[116:119], v[88:91]
    buffer_load_dwordx4 v9, s[12:15], s49 offen offset:2048 lds
    v_mfma_f32_16x16x32_bf16 v[52:55], v[108:111], v[156:159], v[52:55]
    v_mfma_f32_16x16x32_bf16 v[72:75], v[112:115], v[156:159], v[72:75]
    v_mfma_f32_16x16x32_bf16 v[92:95], v[156:159], v[116:119], v[92:95]
    s_sub_u32 s49, 294912, s65
    s_add_u32 m0, s69, 147456
    s_add_u32 s49, s49, s64
    buffer_load_dwordx4 v9, s[12:15], s49 offen offset:0 lds
    s_waitcnt lgkmcnt(0)
    v_mfma_f32_16x16x32_bf16 v[36:39], v[96:99], v[120:123], v[36:39]
    ds_read_b64_tr_b16 v[108:109], v14 offset:12288
    v_mfma_f32_16x16x32_bf16 v[56:59], v[100:103], v[120:123], v[56:59]
    ds_read_b64_tr_b16 v[110:111], v14 offset:12800
    v_mfma_f32_16x16x32_bf16 v[76:79], v[120:123], v[104:107], v[76:79]
    ds_read_b64_tr_b16 v[112:113], v14 offset:13312
    buffer_load_dwordx4 v9, s[12:15], s49 offen offset:1024 lds
    v_mfma_f32_16x16x32_bf16 v[40:43], v[96:99], v[124:127], v[40:43]
    ds_read_b64_tr_b16 v[114:115], v14 offset:13824
    v_mfma_f32_16x16x32_bf16 v[60:63], v[100:103], v[124:127], v[60:63]
    ds_read_b64_tr_b16 v[116:117], v14 offset:14336
    v_mfma_f32_16x16x32_bf16 v[80:83], v[124:127], v[104:107], v[80:83]
    ds_read_b64_tr_b16 v[118:119], v14 offset:14848
    buffer_load_dwordx4 v9, s[12:15], s49 offen offset:2048 lds
    v_mfma_f32_16x16x32_bf16 v[44:47], v[96:99], v[128:131], v[44:47]
    ds_read_b128 v[140:143], v11 offset:40960
    v_mfma_f32_16x16x32_bf16 v[64:67], v[100:103], v[128:131], v[64:67]
    ds_read_b128 v[144:147], v11 offset:45056
    v_mfma_f32_16x16x32_bf16 v[84:87], v[128:131], v[104:107], v[84:87]
    ds_read_b128 v[148:151], v11 offset:49152
    v_mfma_f32_16x16x32_bf16 v[48:51], v[96:99], v[132:135], v[48:51]
    ds_read_b128 v[152:155], v11 offset:53248
    v_mfma_f32_16x16x32_bf16 v[68:71], v[100:103], v[132:135], v[68:71]
    ds_read_b128 v[156:159], v11 offset:57344
    v_mfma_f32_16x16x32_bf16 v[88:91], v[132:135], v[104:107], v[88:91]
    v_mfma_f32_16x16x32_bf16 v[52:55], v[96:99], v[136:139], v[52:55]
    v_mfma_f32_16x16x32_bf16 v[72:75], v[100:103], v[136:139], v[72:75]
    v_mfma_f32_16x16x32_bf16 v[92:95], v[136:139], v[104:107], v[92:95]
    s_waitcnt lgkmcnt(0)
    s_waitcnt vmcnt(18)
    s_barrier
    v_mfma_f32_16x16x32_bf16 v[36:39], v[108:111], v[140:143], v[36:39]
    ds_read_b64_tr_b16 v[96:97], v14 offset:24576
    s_waitcnt vmcnt(7)
    v_cmp_ne_u32 vcc, s3, v212
    s_mov_b32 s55, 0
    s_cbranch_vccnz L_pst_6
L_pst_6_ok:
    v_readfirstlane_b32 s53, v213
    s_lshl_b32 s54, s41, 10
    s_add_u32 s54, s54, 753664
    v_cmp_ne_u32 vcc, s53, v213
    s_nop 0
    s_cmp_eq_u64 vcc, 0
    s_cselect_b32 s44, 1, 0
    s_lshl_b32 s53, s42, 10
    s_add_u32 m0, s53, 159744
    s_add_u32 s53, s53, 159744
    buffer_load_dwordx4 v227, s[36:39], s54 offen sc1 lds
    v_add_u32 v220, s53, v220
    v_add_u32 v221, s53, v221
    v_mfma_f32_16x16x32_bf16 v[56:59], v[112:115], v[140:143], v[56:59]
    ds_read_b64_tr_b16 v[98:99], v14 offset:25088
    buffer_load_dwordx2 v[240:241], v232, s[8:11], 0 offen offset:0
    v_mfma_f32_16x16x32_bf16 v[76:79], v[140:143], v[116:119], v[76:79]
    ds_read_b64_tr_b16 v[100:101], v14 offset:25600
    buffer_load_dwordx2 v[242:243], v232, s[8:11], 0 offen offset:32
    v_mfma_f32_16x16x32_bf16 v[40:43], v[108:111], v[144:147], v[40:43]
    ds_read_b64_tr_b16 v[102:103], v14 offset:26112
    v_mfma_f32_16x16x32_bf16 v[60:63], v[112:115], v[144:147], v[60:63]
    ds_read_b64_tr_b16 v[104:105], v14 offset:26624
    buffer_load_dwordx2 v[244:245], v232, s[8:11], 0 offen offset:64
    v_mfma_f32_16x16x32_bf16 v[80:83], v[144:147], v[116:119], v[80:83]
    ds_read_b64_tr_b16 v[106:107], v14 offset:27136
    v_mfma_f32_16x16x32_bf16 v[44:47], v[108:111], v[148:151], v[44:47]
    ds_read_b128 v[120:123], v12 offset:40960
    buffer_load_dwordx2 v[246:247], v232, s[8:11], 0 offen offset:96
    v_mfma_f32_16x16x32_bf16 v[64:67], v[112:115], v[148:151], v[64:67]
    ds_read_b128 v[124:127], v12 offset:45056
    v_mfma_f32_16x16x32_bf16 v[84:87], v[148:151], v[116:119], v[84:87]
    ds_read_b128 v[128:131], v12 offset:49152
    v_mfma_f32_16x16x32_bf16 v[48:51], v[108:111], v[152:155], v[48:51]
    ds_read_b128 v[132:135], v12 offset:53248
    v_mfma_f32_16x16x32_bf16 v[68:71], v[112:115], v[152:155], v[68:71]
    ds_read_b128 v[136:139], v12 offset:57344
    v_mfma_f32_16x16x32_bf16 v[88:91], v[152:155], v[116:119], v[88:91]
    v_mfma_f32_16x16x32_bf16 v[52:55], v[108:111], v[156:159], v[52:55]
    v_mfma_f32_16x16x32_bf16 v[72:75], v[112:115], v[156:159], v[72:75]
    v_mfma_f32_16x16x32_bf16 v[92:95], v[156:159], v[116:119], v[92:95]
    s_lshl_b32 s52, s41, 16
    s_lshl_b32 s51, s48, 12
    s_add_u32 s52, s52, s51
    s_lshl_b32 s51, s42, 10
    s_add_u32 s52, s52, s51
    s_mov_b64 exec, 0xff
    buffer_load_dword v3, v2, s[36:39], s52 offen sc1
    s_add_u32 s52, s52, 32768
    s_mov_b64 exec, -1
    s_mov_b64 exec, 0xff
    buffer_load_dword v3, v2, s[36:39], s52 offen sc1
    s_mov_b64 exec, -1
    s_lshl_b32 s52, s41, 13
    s_lshl_b32 s51, s40, 8
    s_add_u32 s52, s52, s51
    s_lshl_b32 s51, s42, 11
    s_add_u32 s52, s52, s51
    s_add_u32 s52, s52, 720896
    s_mov_b64 exec, 0x3
    buffer_load_dword v3, v2, s[36:39], s52 offen sc1
    s_mov_b64 exec, -1
    s_lshl_b32 s51, s42, 12
    s_add_u32 s52, s71, s51
    s_mov_b64 exec, 3
    buffer_load_dword v3, v2, s[36:39], s52 offen sc1
    s_add_u32 s52, s52, 16384
    s_mov_b64 exec, -1
    s_cmp_eq_u32 s42, 3
    s_cselect_b32 s51, 4096, 0
    s_add_u32 s52, s52, s51
    s_mov_b64 exec, 3
    buffer_load_dword v3, v2, s[36:39], s52 offen sc1
    s_mov_b64 exec, -1
    s_waitcnt lgkmcnt(0)
    v_mfma_f32_16x16x32_bf16 v[36:39], v[96:99], v[120:123], v[36:39]
    ds_read_b64_tr_b16 v[108:109], v14 offset:36864
    v_mfma_f32_16x16x32_bf16 v[56:59], v[100:103], v[120:123], v[56:59]
    ds_read_b64_tr_b16 v[110:111], v14 offset:37376
    v_mfma_f32_16x16x32_bf16 v[76:79], v[120:123], v[104:107], v[76:79]
    ds_read_b64_tr_b16 v[112:113], v14 offset:37888
    v_mfma_f32_16x16x32_bf16 v[40:43], v[96:99], v[124:127], v[40:43]
    ds_read_b64_tr_b16 v[114:115], v14 offset:38400
    s_add_u32 s52, s43, 0
    s_and_b32 s52, s52, 1
    s_lshl_b32 s52, s52, 18
    s_lshl_b32 s51, s4, 11
    s_add_u32 s52, s52, s51
    s_mov_b64 exec, 0xffff
    buffer_load_dword v3, v2, s[16:19], s52 offen
    s_mov_b64 exec, -1
    v_mfma_f32_16x16x32_bf16 v[60:63], v[100:103], v[124:127], v[60:63]
    ds_read_b64_tr_b16 v[116:117], v14 offset:38912
    v_mfma_f32_16x16x32_bf16 v[80:83], v[124:127], v[104:107], v[80:83]
    ds_read_b64_tr_b16 v[118:119], v14 offset:39424
    v_mfma_f32_16x16x32_bf16 v[44:47], v[96:99], v[128:131], v[44:47]
    ds_read_b128 v[140:143], v13 offset:40960
    s_add_u32 s52, s43, 1
    s_and_b32 s52, s52, 1
    s_lshl_b32 s52, s52, 18
    s_lshl_b32 s51, s4, 11
    s_add_u32 s52, s52, s51
    s_mov_b64 exec, 0xffff
    buffer_load_dword v3, v2, s[16:19], s52 offen
    s_mov_b64 exec, -1
    v_mfma_f32_16x16x32_bf16 v[64:67], v[100:103], v[128:131], v[64:67]
    ds_read_b128 v[144:147], v13 offset:45056
    v_mfma_f32_16x16x32_bf16 v[84:87], v[128:131], v[104:107], v[84:87]
    ds_read_b128 v[148:151], v13 offset:49152
    v_mfma_f32_16x16x32_bf16 v[48:51], v[96:99], v[132:135], v[48:51]
    ds_read_b128 v[152:155], v13 offset:53248
    v_mfma_f32_16x16x32_bf16 v[68:71], v[100:103], v[132:135], v[68:71]
    ds_read_b128 v[156:159], v13 offset:57344
    v_mfma_f32_16x16x32_bf16 v[88:91], v[132:135], v[104:107], v[88:91]
    v_mfma_f32_16x16x32_bf16 v[52:55], v[96:99], v[136:139], v[52:55]
    v_mfma_f32_16x16x32_bf16 v[72:75], v[100:103], v[136:139], v[72:75]
    s_and_b32 s66, s43, 3
    s_mul_i32 s66, s66, 229376
    s_mul_i32 s62, s42, 6144
    s_add_u32 s62, s62, 20480
    s_mul_i32 s63, s42, 12288
    s_add_u32 s63, s63, 110592
    s_lshl_b32 s64, s42, 12
    v_mfma_f32_16x16x32_bf16 v[92:95], v[136:139], v[104:107], v[92:95]
    s_and_b32 s52, s43, 3
    s_lshl_b32 s52, s52, 1
    s_lshr_b32 s51, s43, 2
    s_add_u32 s52, s52, s51
    s_lshl_b32 s52, s52, 7
    s_add_u32 s52, s52, s4
    s_mul_i32 s52, s52, 896
    s_mov_b64 exec, 0x7f
    buffer_load_dword v3, v2, s[20:23], s52 offen
    s_mov_b64 exec, -1
    s_and_b32 s52, s43, 3
    s_lshl_b32 s52, s52, 1
    s_lshr_b32 s51, s43, 2
    s_add_u32 s52, s52, s51
    s_lshl_b32 s52, s52, 7
    s_add_u32 s52, s52, s4
    s_mul_i32 s52, s52, 896
    s_mov_b64 exec, 0x7f
    buffer_load_dword v3, v2, s[24:27], s52 offen
    s_mov_b64 exec, -1
    s_waitcnt lgkmcnt(0)
    s_waitcnt vmcnt(20)
    s_barrier
    v_mfma_f32_16x16x32_bf16 v[36:39], v[108:111], v[140:143], v[36:39]
    ds_read_b64_tr_b16 v[96:97], v15 offset:0
    v_mfma_f32_16x16x32_bf16 v[56:59], v[112:115], v[140:143], v[56:59]
    ds_read_b64_tr_b16 v[98:99], v15 offset:512
    v_mfma_f32_16x16x32_bf16 v[76:79], v[140:143], v[116:119], v[76:79]
    ds_read_b64_tr_b16 v[100:101], v15 offset:1024
    v_mfma_f32_16x16x32_bf16 v[40:43], v[108:111], v[144:147], v[40:43]
    ds_read_b64_tr_b16 v[102:103], v15 offset:1536
    v_mfma_f32_16x16x32_bf16 v[60:63], v[112:115], v[144:147], v[60:63]
    ds_read_b64_tr_b16 v[104:105], v15 offset:2048
    v_mfma_f32_16x16x32_bf16 v[80:83], v[144:147], v[116:119], v[80:83]
    ds_read_b64_tr_b16 v[106:107], v15 offset:2560
    v_mfma_f32_16x16x32_bf16 v[44:47], v[108:111], v[148:151], v[44:47]
    ds_read_b128 v[120:123], v10 offset:0
    v_mfma_f32_16x16x32_bf16 v[64:67], v[112:115], v[148:151], v[64:67]
    ds_read_b128 v[124:127], v10 offset:4096
    v_mfma_f32_16x16x32_bf16 v[84:87], v[148:151], v[116:119], v[84:87]
    ds_read_b128 v[128:131], v10 offset:8192
    v_mfma_f32_16x16x32_bf16 v[48:51], v[108:111], v[152:155], v[48:51]
    ds_read_b128 v[132:135], v10 offset:12288
    v_mfma_f32_16x16x32_bf16 v[68:71], v[112:115], v[152:155], v[68:71]
    ds_read_b128 v[136:139], v10 offset:16384
    v_mfma_f32_16x16x32_bf16 v[88:91], v[152:155], v[116:119], v[88:91]
    v_mfma_f32_16x16x32_bf16 v[52:55], v[108:111], v[156:159], v[52:55]
    v_mfma_f32_16x16x32_bf16 v[72:75], v[112:115], v[156:159], v[72:75]
    v_mfma_f32_16x16x32_bf16 v[92:95], v[156:159], v[116:119], v[92:95]
    s_waitcnt lgkmcnt(0)
    v_mfma_f32_16x16x32_bf16 v[36:39], v[96:99], v[120:123], v[36:39]
    ds_read_b64_tr_b16 v[108:109], v15 offset:12288
    v_mfma_f32_16x16x32_bf16 v[56:59], v[100:103], v[120:123], v[56:59]
    ds_read_b64_tr_b16 v[110:111], v15 offset:12800
    v_mfma_f32_16x16x32_bf16 v[76:79], v[120:123], v[104:107], v[76:79]
    ds_read_b64_tr_b16 v[112:113], v15 offset:13312
    v_mfma_f32_16x16x32_bf16 v[40:43], v[96:99], v[124:127], v[40:43]
    ds_read_b64_tr_b16 v[114:115], v15 offset:13824
    v_mfma_f32_16x16x32_bf16 v[60:63], v[100:103], v[124:127], v[60:63]
    ds_read_b64_tr_b16 v[116:117], v15 offset:14336
    v_mfma_f32_16x16x32_bf16 v[80:83], v[124:127], v[104:107], v[80:83]
    ds_read_b64_tr_b16 v[118:119], v15 offset:14848
    v_mfma_f32_16x16x32_bf16 v[44:47], v[96:99], v[128:131], v[44:47]
    ds_read_b128 v[140:143], v11 offset:0
    v_mfma_f32_16x16x32_bf16 v[64:67], v[100:103], v[128:131], v[64:67]
    ds_read_b128 v[144:147], v11 offset:4096
    v_mfma_f32_16x16x32_bf16 v[84:87], v[128:131], v[104:107], v[84:87]
    ds_read_b128 v[148:151], v11 offset:8192
    v_mfma_f32_16x16x32_bf16 v[48:51], v[96:99], v[132:135], v[48:51]
    ds_read_b128 v[152:155], v11 offset:12288
    v_mfma_f32_16x16x32_bf16 v[68:71], v[100:103], v[132:135], v[68:71]
    ds_read_b128 v[156:159], v11 offset:16384
    v_mfma_f32_16x16x32_bf16 v[88:91], v[132:135], v[104:107], v[88:91]
    v_mfma_f32_16x16x32_bf16 v[52:55], v[96:99], v[136:139], v[52:55]
    v_mfma_f32_16x16x32_bf16 v[72:75], v[100:103], v[136:139], v[72:75]
    v_mfma_f32_16x16x32_bf16 v[92:95], v[136:139], v[104:107], v[92:95]
    s_waitcnt lgkmcnt(0)
    s_waitcnt vmcnt(14)
    s_barrier
    v_mfma_f32_16x16x32_bf16 v[36:39], v[108:111], v[140:143], v[36:39]
    ds_read_b64_tr_b16 v[96:97], v15 offset:24576
    v_mfma_f32_16x16x32_bf16 v[56:59], v[112:115], v[140:143], v[56:59]
    ds_read_b64_tr_b16 v[98:99], v15 offset:25088
    v_mfma_f32_16x16x32_bf16 v[76:79], v[140:143], v[116:119], v[76:79]
    ds_read_b64_tr_b16 v[100:101], v15 offset:25600
    v_mfma_f32_16x16x32_bf16 v[40:43], v[108:111], v[144:147], v[40:43]
    ds_read_b64_tr_b16 v[102:103], v15 offset:26112
    v_mfma_f32_16x16x32_bf16 v[60:63], v[112:115], v[144:147], v[60:63]
    ds_read_b64_tr_b16 v[104:105], v15 offset:26624
    v_mfma_f32_16x16x32_bf16 v[80:83], v[144:147], v[116:119], v[80:83]
    ds_read_b64_tr_b16 v[106:107], v15 offset:27136
    v_mfma_f32_16x16x32_bf16 v[44:47], v[108:111], v[148:151], v[44:47]
    ds_read_b128 v[120:123], v12 offset:0
    v_mfma_f32_16x16x32_bf16 v[64:67], v[112:115], v[148:151], v[64:67]
    ds_read_b128 v[124:127], v12 offset:4096
    v_mfma_f32_16x16x32_bf16 v[84:87], v[148:151], v[116:119], v[84:87]
    ds_read_b128 v[128:131], v12 offset:8192
    v_mfma_f32_16x16x32_bf16 v[48:51], v[108:111], v[152:155], v[48:51]
    ds_read_b128 v[132:135], v12 offset:12288
    v_mfma_f32_16x16x32_bf16 v[68:71], v[112:115], v[152:155], v[68:71]
    ds_read_b128 v[136:139], v12 offset:16384
    v_mfma_f32_16x16x32_bf16 v[88:91], v[152:155], v[116:119], v[88:91]
    v_mfma_f32_16x16x32_bf16 v[52:55], v[108:111], v[156:159], v[52:55]
    v_mfma_f32_16x16x32_bf16 v[72:75], v[112:115], v[156:159], v[72:75]
    v_mfma_f32_16x16x32_bf16 v[92:95], v[156:159], v[116:119], v[92:95]
    s_waitcnt lgkmcnt(0)
    v_mfma_f32_16x16x32_bf16 v[36:39], v[96:99], v[120:123], v[36:39]
    ds_read_b64_tr_b16 v[108:109], v15 offset:36864
    v_mfma_f32_16x16x32_bf16 v[56:59], v[100:103], v[120:123], v[56:59]
    ds_read_b64_tr_b16 v[110:111], v15 offset:37376
    v_mfma_f32_16x16x32_bf16 v[76:79], v[120:123], v[104:107], v[76:79]
    ds_read_b64_tr_b16 v[112:113], v15 offset:37888
    v_mfma_f32_16x16x32_bf16 v[40:43], v[96:99], v[124:127], v[40:43]
    ds_read_b64_tr_b16 v[114:115], v15 offset:38400
    v_mfma_f32_16x16x32_bf16 v[60:63], v[100:103], v[124:127], v[60:63]
    ds_read_b64_tr_b16 v[116:117], v15 offset:38912
    v_mfma_f32_16x16x32_bf16 v[80:83], v[124:127], v[104:107], v[80:83]
    ds_read_b64_tr_b16 v[118:119], v15 offset:39424
    v_mfma_f32_16x16x32_bf16 v[44:47], v[96:99], v[128:131], v[44:47]
    ds_read_b128 v[140:143], v13 offset:0
    v_mfma_f32_16x16x32_bf16 v[64:67], v[100:103], v[128:131], v[64:67]
    ds_read_b128 v[144:147], v13 offset:4096
    v_mfma_f32_16x16x32_bf16 v[84:87], v[128:131], v[104:107], v[84:87]
    ds_read_b128 v[148:151], v13 offset:8192
    v_mfma_f32_16x16x32_bf16 v[48:51], v[96:99], v[132:135], v[48:51]
    ds_read_b128 v[152:155], v13 offset:12288
    v_mfma_f32_16x16x32_bf16 v[68:71], v[100:103], v[132:135], v[68:71]
    ds_read_b128 v[156:159], v13 offset:16384
    v_mfma_f32_16x16x32_bf16 v[88:91], v[132:135], v[104:107], v[88:91]
    v_mfma_f32_16x16x32_bf16 v[52:55], v[96:99], v[136:139], v[52:55]
    v_mfma_f32_16x16x32_bf16 v[72:75], v[100:103], v[136:139], v[72:75]
    v_mfma_f32_16x16x32_bf16 v[92:95], v[136:139], v[104:107], v[92:95]
    s_waitcnt lgkmcnt(0)
    v_mfma_f32_16x16x32_bf16 v[36:39], v[108:111], v[140:143], v[36:39]
    s_waitcnt vmcnt(13)
    ds_read_b64 v[200:201], v220 offset:0
    v_mfma_f32_16x16x32_bf16 v[56:59], v[112:115], v[140:143], v[56:59]
    ds_read_b64 v[202:203], v220 offset:128
    s_lshl_b32 s68, s42, 14
    s_add_u32 s68, s68, 45056
    s_lshl_b32 s69, s42, 17
    s_add_u32 m0, s68, 0
    s_add_u32 s50, s69, 0
    buffer_load_dwordx4 v228, s[16:19], s50 offen lds
    v_mfma_f32_16x16x32_bf16 v[76:79], v[140:143], v[116:119], v[76:79]
    ds_read_b64 v[204:205], v220 offset:256
    v_mfma_f32_16x16x32_bf16 v[40:43], v[108:111], v[144:147], v[40:43]
    ds_read_b64 v[206:207], v220 offset:384
    ds_read_b64 v[208:209], v220 offset:512
    v_mfma_f32_16x16x32_bf16 v[60:63], v[112:115], v[144:147], v[60:63]
    ds_read_b128 v[160:163], v221 offset:0
    v_mfma_f32_16x16x32_bf16 v[80:83], v[144:147], v[116:119], v[80:83]
    ds_read_b128 v[164:167], v221 offset:16
    v_mfma_f32_16x16x32_bf16 v[44:47], v[108:111], v[148:151], v[44:47]
    ds_read_b128 v[168:171], v221 offset:128
    ds_read_b128 v[172:175], v221 offset:144
    v_mfma_f32_16x16x32_bf16 v[64:67], v[112:115], v[148:151], v[64:67]
    ds_read_b128 v[176:179], v221 offset:256
    s_add_u32 m0, s68, 1024
    s_add_u32 s50, s69, 8192
    buffer_load_dwordx4 v229, s[16:19], s50 offen lds
    v_mfma_f32_16x16x32_bf16 v[84:87], v[148:151], v[116:119], v[84:87]
    ds_read_b128 v[180:183], v221 offset:272
    v_mfma_f32_16x16x32_bf16 v[48:51], v[108:111], v[152:155], v[48:51]
    ds_read_b128 v[184:187], v221 offset:384
    ds_read_b128 v[188:191], v221 offset:400
    v_mfma_f32_16x16x32_bf16 v[68:71], v[112:115], v[152:155], v[68:71]
    ds_read_b128 v[192:195], v221 offset:512
    v_mfma_f32_16x16x32_bf16 v[88:91], v[152:155], v[116:119], v[88:91]
    ds_read_b128 v[196:199], v221 offset:528
    v_mfma_f32_16x16x32_bf16 v[52:55], v[108:111], v[156:159], v[52:55]
    v_mfma_f32_16x16x32_bf16 v[72:75], v[112:115], v[156:159], v[72:75]
    v_mfma_f32_16x16x32_bf16 v[92:95], v[156:159], v[116:119], v[92:95]
    s_barrier
    s_nop 4
    v_mov_b32_dpp v4, v36 row_newbcast:0 row_mask:0xf bank_mask:0xf
    v_mov_b32_dpp v5, v37 row_newbcast:0 row_mask:0xf bank_mask:0xf
    v_mov_b32_dpp v6, v38 row_newbcast:0 row_mask:0xf bank_mask:0xf
    v_mov_b32_dpp v7, v39 row_newbcast:0 row_mask:0xf bank_mask:0xf
    v_mov_b32_dpp v8, v56 row_newbcast:0 row_mask:0xf bank_mask:0xf
    v_mov_b32_dpp v9, v57 row_newbcast:0 row_mask:0xf bank_mask:0xf
    v_mov_b32_dpp v10, v58 row_newbcast:0 row_mask:0xf bank_mask:0xf
    v_mov_b32_dpp v11, v59 row_newbcast:0 row_mask:0xf bank_mask:0xf
    v_mov_b32 v12, v76
    v_mov_b32 v13, v76
    s_mov_b32 s70, 0x3eb8aa3b
    s_nop 0
    v_permlane16_swap_b32 v12, v13
    s_nop 0
    v_mov_b32 v13, v12
    s_nop 1
    v_permlane32_swap_b32 v12, v13
    s_waitcnt lgkmcnt(0)
    v_pk_fma_f32 v[56:57], v[8:9], v[200:201], v[56:57] op_sel:[0,0,0] op_sel_hi:[1,0,1]
    v_pk_fma_f32 v[58:59], v[10:11], v[200:201], v[58:59] op_sel:[0,0,0] op_sel_hi:[1,0,1]
    v_pk_fma_f32 v[60:61], v[8:9], v[202:203], v[60:61] op_sel:[0,0,0] op_sel_hi:[1,0,1]
    v_pk_fma_f32 v[62:63], v[10:11], v[202:203], v[62:63] op_sel:[0,0,0] op_sel_hi:[1,0,1]
    v_pk_mul_f32 v[56:57], v[56:57], v[200:201] op_sel:[0,1] op_sel_hi:[1,1]
    v_pk_mul_f32 v[58:59], v[58:59], v[200:201] op_sel:[0,1] op_sel_hi:[1,1]
    v_pk_fma_f32 v[40:41], v[4:5], v[202:203], v[40:41] op_sel:[0,0,0] op_sel_hi:[1,0,1]
    v_pk_fma_f32 v[42:43], v[6:7], v[202:203], v[42:43] op_sel:[0,0,0] op_sel_hi:[1,0,1]
    v_pk_mul_f32 v[60:61], v[60:61], v[202:203] op_sel:[0,1] op_sel_hi:[1,1]
    v_pk_mul_f32 v[62:63], v[62:63], v[202:203] op_sel:[0,1] op_sel_hi:[1,1]
    v_cvt_pk_bf16_f32 v104, v56, v57
    v_cvt_pk_bf16_f32 v105, v58, v59
    v_pk_fma_f32 v[64:65], v[8:9], v[204:205], v[64:65] op_sel:[0,0,0] op_sel_hi:[1,0,1]
    v_pk_fma_f32 v[66:67], v[10:11], v[204:205], v[66:67] op_sel:[0,0,0] op_sel_hi:[1,0,1]
    v_pk_mul_f32 v[40:41], v[40:41], v[202:203] op_sel:[0,1] op_sel_hi:[1,1]
    v_pk_mul_f32 v[42:43], v[42:43], v[202:203] op_sel:[0,1] op_sel_hi:[1,1]
    v_cvt_pk_bf16_f32 v106, v60, v61
    v_cvt_pk_bf16_f32 v107, v62, v63
    v_pk_fma_f32 v[44:45], v[4:5], v[204:205], v[44:45] op_sel:[0,0,0] op_sel_hi:[1,0,1]
    v_pk_fma_f32 v[46:47], v[6:7], v[204:205], v[46:47] op_sel:[0,0,0] op_sel_hi:[1,0,1]
    v_pk_mul_f32 v[64:65], v[64:65], v[204:205] op_sel:[0,1] op_sel_hi:[1,1]
    v_pk_mul_f32 v[66:67], v[66:67], v[204:205] op_sel:[0,1] op_sel_hi:[1,1]
    v_cvt_pk_bf16_f32 v96, v40, v41
    v_cvt_pk_bf16_f32 v97, v42, v43
    v_pk_fma_f32 v[68:69], v[8:9], v[206:207], v[68:69] op_sel:[0,0,0] op_sel_hi:[1,0,1]
    v_pk_fma_f32 v[70:71], v[10:11], v[206:207], v[70:71] op_sel:[0,0,0] op_sel_hi:[1,0,1]
    v_pk_mul_f32 v[44:45], v[44:45], v[204:205] op_sel:[0,1] op_sel_hi:[1,1]
    v_pk_mul_f32 v[46:47], v[46:47], v[204:205] op_sel:[0,1] op_sel_hi:[1,1]
    v_cvt_pk_bf16_f32 v108, v64, v65
    v_cvt_pk_bf16_f32 v109, v66, v67
    v_pk_fma_f32 v[48:49], v[4:5], v[206:207], v[48:49] op_sel:[0,0,0] op_sel_hi:[1,0,1]
    v_pk_fma_f32 v[50:51], v[6:7], v[206:207], v[50:51] op_sel:[0,0,0] op_sel_hi:[1,0,1]
    v_pk_mul_f32 v[68:69], v[68:69], v[206:207] op_sel:[0,1] op_sel_hi:[1,1]
    v_pk_mul_f32 v[70:71], v[70:71], v[206:207] op_sel:[0,1] op_sel_hi:[1,1]
    v_cvt_pk_bf16_f32 v98, v44, v45
    v_cvt_pk_bf16_f32 v99, v46, v47
    s_add_u32 m0, s68, 2048
    s_add_u32 s50, s69, 16384
    buffer_load_dwordx4 v228, s[16:19], s50 offen lds
    v_pk_fma_f32 v[72:73], v[8:9], v[208:209], v[72:73] op_sel:[0,0,0] op_sel_hi:[1,0,1]
    v_pk_fma_f32 v[74:75], v[10:11], v[208:209], v[74:75] op_sel:[0,0,0] op_sel_hi:[1,0,1]
    v_pk_mul_f32 v[48:49], v[48:49], v[206:207] op_sel:[0,1] op_sel_hi:[1,1]
    v_pk_mul_f32 v[50:51], v[50:51], v[206:207] op_sel:[0,1] op_sel_hi:[1,1]
    v_cvt_pk_bf16_f32 v110, v68, v69
    v_cvt_pk_bf16_f32 v111, v70, v71
    s_add_u32 m0, s68, 3072
    s_add_u32 s50, s69, 24576
    buffer_load_dwordx4 v229, s[16:19], s50 offen lds
    v_pk_fma_f32 v[52:53], v[4:5], v[208:209], v[52:53] op_sel:[0,0,0] op_sel_hi:[1,0,1]
    v_pk_fma_f32 v[54:55], v[6:7], v[208:209], v[54:55] op_sel:[0,0,0] op_sel_hi:[1,0,1]
    v_pk_mul_f32 v[72:73], v[72:73], v[208:209] op_sel:[0,1] op_sel_hi:[1,1]
    v_pk_mul_f32 v[74:75], v[74:75], v[208:209] op_sel:[0,1] op_sel_hi:[1,1]
    v_cvt_pk_bf16_f32 v100, v48, v49
    v_cvt_pk_bf16_f32 v101, v50, v51
    s_add_u32 m0, s68, 4096
    s_add_u32 s50, s69, 32768
    buffer_load_dwordx4 v228, s[16:19], s50 offen lds
    v_pk_mul_f32 v[52:53], v[52:53], v[208:209] op_sel:[0,1] op_sel_hi:[1,1]
    v_pk_mul_f32 v[54:55], v[54:55], v[208:209] op_sel:[0,1] op_sel_hi:[1,1]
    v_cvt_pk_bf16_f32 v112, v72, v73
    v_cvt_pk_bf16_f32 v113, v74, v75
    s_add_u32 m0, s68, 5120
    s_add_u32 s50, s69, 40960
    buffer_load_dwordx4 v229, s[16:19], s50 offen lds
    v_cvt_pk_bf16_f32 v102, v52, v53
    v_cvt_pk_bf16_f32 v103, v54, v55
    s_add_u32 m0, s68, 6144
    s_add_u32 s50, s69, 49152
    buffer_load_dwordx4 v228, s[16:19], s50 offen lds
    s_nop 1
    v_mfma_f32_16x16x16_bf16 v[128:131], v[104:105], v[96:97], v[24:27]
    v_mfma_f32_16x16x16_bf16 v[132:135], v[106:107], v[96:97], v[16:19]
    v_mfma_f32_16x16x16_bf16 v[136:139], v[106:107], v[98:99], v[20:23]
    v_mfma_f32_16x16x16_bf16 v[140:143], v[108:109], v[98:99], v[16:19]
    v_mfma_f32_16x16x16_bf16 v[144:147], v[104:105], v[100:101], v[28:31]
    v_mfma_f32_16x16x16_bf16 v[148:151], v[110:111], v[100:101], v[16:19]
    v_mfma_f32_16x16x16_bf16 v[152:155], v[110:111], v[102:103], v[20:23]
    v_mfma_f32_16x16x16_bf16 v[156:159], v[112:113], v[102:103], v[16:19]
    v_fmac_f32 v76, v160, v12
    v_fmac_f32 v77, v162, v12
    v_fmac_f32 v78, v164, v12
    v_fmac_f32 v79, v166, v12
    s_add_u32 m0, s68, 7168
    s_add_u32 s50, s69, 57344
    buffer_load_dwordx4 v229, s[16:19], s50 offen lds
    v_fmac_f32 v80, v168, v12
    v_fmac_f32 v81, v170, v12
    v_fmac_f32 v82, v172, v12
    v_fmac_f32 v83, v174, v12
    v_mul_f32 v76, v161, v76
    v_mul_f32 v77, v163, v77
    v_mul_f32 v78, v165, v78
    v_mul_f32 v79, v167, v79
    s_add_u32 m0, s68, 8192
    s_add_u32 s50, s69, 65536
    buffer_load_dwordx4 v228, s[16:19], s50 offen lds
    v_fmac_f32 v84, v176, v12
    v_fmac_f32 v85, v178, v12
    v_fmac_f32 v86, v180, v12
    v_fmac_f32 v87, v182, v12
    v_mul_f32 v80, v169, v80
    v_mul_f32 v81, v171, v81
    v_mul_f32 v82, v173, v82
    v_mul_f32 v83, v175, v83
    v_cvt_pk_bf16_f32 v114, v76, v77
    v_cvt_pk_bf16_f32 v115, v78, v79
    s_add_u32 m0, s68, 9216
    s_add_u32 s50, s69, 73728
    buffer_load_dwordx4 v229, s[16:19], s50 offen lds
    v_fmac_f32 v88, v184, v12
    v_fmac_f32 v89, v186, v12
    v_fmac_f32 v90, v188, v12
    v_fmac_f32 v91, v190, v12
    v_mul_f32 v84, v177, v84
    v_mul_f32 v85, v179, v85
    v_mul_f32 v86, v181, v86
    v_mul_f32 v87, v183, v87
    v_cvt_pk_bf16_f32 v116, v80, v81
    v_cvt_pk_bf16_f32 v117, v82, v83
    v_fmac_f32 v92, v192, v12
    v_fmac_f32 v93, v194, v12
    v_fmac_f32 v94, v196, v12
    v_fmac_f32 v95, v198, v12
    v_mul_f32 v88, v185, v88
    v_mul_f32 v89, v187, v89
    v_mul_f32 v90, v189, v90
    v_mul_f32 v91, v191, v91
    v_cvt_pk_bf16_f32 v118, v84, v85
    v_cvt_pk_bf16_f32 v119, v86, v87
    v_mul_f32 v92, v193, v92
    v_mul_f32 v93, v195, v93
    v_mul_f32 v94, v197, v94
    v_mul_f32 v95, v199, v95
    v_cvt_pk_bf16_f32 v122, v88, v89
    v_cvt_pk_bf16_f32 v123, v90, v91
    v_cvt_pk_bf16_f32 v124, v92, v93
    v_cvt_pk_bf16_f32 v125, v94, v95
    v_mov_b32 v120, v114
    v_mov_b32 v121, v115
    v_mov_b32 v28, v230
    v_xor_b32 v29, 32, v230
    v_xor_b32 v30, 64, v230
    v_xor_b32 v31, 96, v230
    v_max_f32 v128, v128, v132
    v_max_f32 v129, v129, v133
    v_max_f32 v130, v130, v134
    v_max_f32 v131, v131, v135
    v_max_f32 v136, v136, v140
    v_max_f32 v137, v137, v141
    v_max_f32 v138, v138, v142
    v_max_f32 v139, v139, v143
    v_max_f32 v144, v144, v148
    v_max_f32 v145, v145, v149
    v_max_f32 v146, v146, v150
    v_max_f32 v147, v147, v151
    v_max_f32 v152, v152, v156
    v_max_f32 v153, v153, v157
    v_max_f32 v154, v154, v158
    v_max_f32 v155, v155, v159
    v_max3_f32 v36, v128, v129, v130
    v_max3_f32 v37, v136, v137, v138
    v_max3_f32 v38, v144, v145, v146
    v_max3_f32 v39, v152, v153, v154
    v_max_f32 v36, v36, v131
    v_max_f32 v37, v37, v139
    v_max_f32 v38, v38, v147
    v_max_f32 v39, v39, v155
    v_mov_b32 v40, v36
    v_mov_b32 v41, v37
    v_mov_b32 v42, v38
    v_mov_b32 v43, v39
    s_nop 0
    v_permlane16_swap_b32 v36, v40
    v_permlane16_swap_b32 v37, v41
    v_permlane16_swap_b32 v38, v42
    v_permlane16_swap_b32 v39, v43
    v_max_f32 v36, v36, v40
    v_max_f32 v37, v37, v41
    v_max_f32 v38, v38, v42
    v_max_f32 v39, v39, v43
    v_mov_b32 v40, v36
    v_mov_b32 v41, v37
    v_mov_b32 v42, v38
    v_mov_b32 v43, v39
    s_nop 0
    v_permlane32_swap_b32 v36, v40
    v_permlane32_swap_b32 v37, v41
    v_permlane32_swap_b32 v38, v42
    v_permlane32_swap_b32 v39, v43
    v_max_f32 v36, v36, v40
    v_max_f32 v37, v37, v41
    v_max_f32 v38, v38, v42
    v_max_f32 v39, v39, v43
    v_mul_f32 v36, 0xbeb8aa3b, v36
    v_mul_f32 v37, 0xbeb8aa3b, v37
    v_mul_f32 v38, 0xbeb8aa3b, v38
    v_mul_f32 v39, 0xbeb8aa3b, v39
    v_fma_f32 v128, v128, s70, v36
    v_fma_f32 v129, v129, s70, v36
    v_fma_f32 v130, v130, s70, v36
    v_fma_f32 v131, v131, s70, v36
    v_fma_f32 v136, v136, s70, v37
    v_fma_f32 v137, v137, s70, v37
    v_fma_f32 v138, v138, s70, v37
    v_fma_f32 v139, v139, s70, v37
    v_fma_f32 v144, v144, s70, v38
    v_fma_f32 v145, v145, s70, v38
    v_fma_f32 v146, v146, s70, v38
    v_fma_f32 v147, v147, s70, v38
    v_fma_f32 v152, v152, s70, v39
    v_fma_f32 v153, v153, s70, v39
    v_fma_f32 v154, v154, s70, v39
    v_fma_f32 v155, v155, s70, v39
    v_exp_f32 v128, v128
    v_exp_f32 v129, v129
    v_exp_f32 v130, v130
    v_exp_f32 v131, v131
    v_exp_f32 v136, v136
    v_exp_f32 v137, v137
    v_exp_f32 v138, v138
    v_exp_f32 v139, v139
    v_cvt_pk_bf16_f32 v44, v128, v129
    v_cvt_pk_bf16_f32 v45, v130, v131
    v_and_b32 v46, v34, v44
    v_and_b32 v47, v35, v45
    v_and_b32 v48, v32, v44
    v_and_b32 v49, v33, v45
    v_exp_f32 v144, v144
    v_exp_f32 v145, v145
    v_exp_f32 v146, v146
    v_exp_f32 v147, v147
    v_cvt_pk_bf16_f32 v52, v136, v137
    v_cvt_pk_bf16_f32 v53, v138, v139
    v_and_b32 v54, v34, v52
    v_and_b32 v55, v35, v53
    v_and_b32 v56, v32, v52
    v_and_b32 v57, v33, v53
    v_mfma_f32_16x16x16_bf16 v[132:135], v[222:223], v[44:45], 0
    v_mfma_f32_16x16x32_bf16 v[76:79], v[114:117], v[46:49], 0
    v_exp_f32 v152, v152
    v_exp_f32 v153, v153
    v_exp_f32 v154, v154
    v_exp_f32 v155, v155
    v_cvt_pk_bf16_f32 v60, v144, v145
    v_cvt_pk_bf16_f32 v61, v146, v147
    v_and_b32 v62, v34, v60
    v_and_b32 v63, v35, v61
    v_and_b32 v64, v32, v60
    v_and_b32 v65, v33, v61
    v_mfma_f32_16x16x16_bf16 v[140:143], v[222:223], v[52:53], 0
    v_mfma_f32_16x16x32_bf16 v[80:83], v[116:119], v[54:57], 0
    s_nop 0
    v_cvt_pk_bf16_f32 v68, v152, v153
    v_cvt_pk_bf16_f32 v69, v154, v155
    v_and_b32 v70, v34, v68
    v_and_b32 v71, v35, v69
    v_and_b32 v72, v32, v68
    v_and_b32 v73, v33, v69
    v_mfma_f32_16x16x16_bf16 v[148:151], v[222:223], v[60:61], 0
    v_mfma_f32_16x16x32_bf16 v[84:87], v[120:123], v[62:65], 0
    s_nop 0
    v_mfma_f32_16x16x16_bf16 v[156:159], v[222:223], v[68:69], 0
    v_mfma_f32_16x16x32_bf16 v[88:91], v[122:125], v[70:73], 0
    v_rcp_f32 v132, v132
    v_rcp_f32 v140, v140
    v_pk_mul_f32 v[76:77], v[76:77], v[132:133] op_sel:[0,0] op_sel_hi:[1,0]
    v_pk_mul_f32 v[78:79], v[78:79], v[132:133] op_sel:[0,0] op_sel_hi:[1,0]
    v_pk_mul_f32 v[80:81], v[80:81], v[140:141] op_sel:[0,0] op_sel_hi:[1,0]
    v_pk_mul_f32 v[82:83], v[82:83], v[140:141] op_sel:[0,0] op_sel_hi:[1,0]
    v_rcp_f32 v148, v148
    v_cvt_pk_bf16_f32 v96, v76, v77
    v_cvt_pk_bf16_f32 v97, v78, v79
    v_cvt_pk_bf16_f32 v100, v80, v81
    v_cvt_pk_bf16_f32 v101, v82, v83
    v_rcp_f32 v156, v156
    v_pk_mul_f32 v[84:85], v[84:85], v[148:149] op_sel:[0,0] op_sel_hi:[1,0]
    v_pk_mul_f32 v[86:87], v[86:87], v[148:149] op_sel:[0,0] op_sel_hi:[1,0]
    v_pk_mul_f32 v[88:89], v[88:89], v[156:157] op_sel:[0,0] op_sel_hi:[1,0]
    v_pk_mul_f32 v[90:91], v[90:91], v[156:157] op_sel:[0,0] op_sel_hi:[1,0]
    v_cvt_pk_bf16_f32 v98, v84, v85
    v_cvt_pk_bf16_f32 v99, v86, v87
    v_cvt_pk_bf16_f32 v102, v88, v89
    v_cvt_pk_bf16_f32 v103, v90, v91
    s_mov_b32 s49, 32768
    v_permlane16_swap_b32 v96, v98
    v_permlane16_swap_b32 v97, v99
    v_permlane16_swap_b32 v100, v102
    v_permlane16_swap_b32 v101, v103
    s_cmp_eq_u32 s44, 0
    s_cbranch_scc1 L_slow_7
    buffer_store_dwordx4 v[96:99], v238, s[36:39], 0 offen
    buffer_store_dwordx4 v[100:103], v238, s[36:39], s49 offen
L_slow_7_j:
    s_add_u32 m0, s68, 10240
    s_add_u32 s50, s69, 81920
    buffer_load_dwordx4 v228, s[16:19], s50 offen lds
    s_add_u32 m0, s68, 11264
    s_add_u32 s50, s69, 90112
    buffer_load_dwordx4 v229, s[16:19], s50 offen lds
    s_add_u32 m0, s68, 12288
    s_add_u32 s50, s69, 98304
    buffer_load_dwordx4 v228, s[16:19], s50 offen lds
    s_lshl_b32 s49, s42, 10
    s_add_u32 s49, s49, 159744
    v_subrev_u32 v26, s49, v234
    v_add_u32 v24, s62, v26
    v_add_u32 v25, s63, v26
    v_add_u32 v26, s64, v26
    s_cmp_lt_u32 s46, 8
    s_cselect_b32 s6, -1, 0
    s_cselect_b32 s7, 0, -1
    s_lshl_b32 s49, s41, 16
    s_lshr_b32 s50, s42, 1
    s_lshl_b32 s50, s50, 15
    s_add_u32 s49, s49, s50
    s_add_u32 s57, s49, 0
    s_lshl_b32 s50, s40, 12
    s_add_u32 s12, s57, s50
    s_lshl_b32 s13, s41, 13
    s_lshl_b32 s50, s42, 11
    s_add_u32 s13, s13, s50
    s_add_u32 s13, s13, 720896
    s_lshl_b32 s50, s40, 8
    s_add_u32 s14, s13, s50
    s_waitcnt vmcnt(24)
    v_and_b32 v255, 0xffff0000, v247
    v_lshlrev_b32 v254, 16, v247
    v_and_b32 v253, 0xffff0000, v246
    v_lshlrev_b32 v252, 16, v246
    v_and_b32 v251, 0xffff0000, v245
    v_lshlrev_b32 v250, 16, v245
    v_and_b32 v249, 0xffff0000, v244
    v_lshlrev_b32 v248, 16, v244
    v_and_b32 v247, 0xffff0000, v243
    v_lshlrev_b32 v246, 16, v243
    v_and_b32 v245, 0xffff0000, v242
    v_lshlrev_b32 v244, 16, v242
    v_and_b32 v243, 0xffff0000, v241
    v_lshlrev_b32 v242, 16, v241
    v_and_b32 v241, 0xffff0000, v240
    v_lshlrev_b32 v240, 16, v240
    v_mov_b32 v16, 0
    v_mov_b32 v17, s3
    s_waitcnt vmcnt(3)
    s_mov_b64 exec, 1
    s_cmp_eq_u32 s44, 0
    s_cbranch_scc1 L_slow_8
    buffer_store_dword v17, v16, s[36:39], s5 offen
L_slow_8_j:
    s_mov_b64 exec, -1
    s_add_u32 m0, s68, 13312
    s_add_u32 s50, s69, 106496
    buffer_load_dwordx4 v229, s[16:19], s50 offen lds
    s_add_u32 m0, s68, 14336
    s_add_u32 s50, s69, 114688
    buffer_load_dwordx4 v228, s[16:19], s50 offen lds
    s_add_u32 m0, s68, 15360
    s_add_u32 s50, s69, 122880
    buffer_load_dwordx4 v229, s[16:19], s50 offen lds
    s_add_u32 m0, s62, 0
    s_nop 0
    buffer_load_dwordx4 v233, s[20:23], s66 offen lds
    s_add_u32 m0, s62, 1024
    s_nop 0
    buffer_load_dwordx4 v233, s[24:27], s66 offen lds
    s_add_u32 s66, s66, 57344
    s_cmp_lt_u32 s66, 917504
    s_cselect_b32 s66, s66, 0
    s_add_u32 m0, s62, 2048
    s_nop 0
    buffer_load_dwordx4 v233, s[20:23], s66 offen lds
    s_add_u32 m0, s62, 3072
    s_nop 0
    buffer_load_dwordx4 v233, s[24:27], s66 offen lds
    s_add_u32 s66, s66, 57344
    s_cmp_lt_u32 s66, 917504
    s_cselect_b32 s66, s66, 0
    s_add_u32 m0, s62, 4096
    s_nop 0
    buffer_load_dwordx4 v233, s[20:23], s66 offen lds
    s_add_u32 m0, s62, 5120
    s_nop 0
    buffer_load_dwordx4 v233, s[24:27], s66 offen lds
    s_add_u32 s66, s66, 57344
    s_cmp_lt_u32 s66, 917504
    s_cselect_b32 s66, s66, 0
    s_add_u32 s51, s71, 0
    buffer_load_dword v18, v239, s[36:39], s51 offen sc1
    s_waitcnt vmcnt(7)
    s_barrier
    ds_read_b64_tr_b16 a[128:129], v28 offset:0
    ds_read_b64_tr_b16 a[130:131], v28 offset:512
    ds_read_b64_tr_b16 a[132:133], v29 offset:0
    ds_read_b64_tr_b16 a[134:135], v29 offset:512
    ds_read_b64_tr_b16 a[136:137], v30 offset:0
    ds_read_b64_tr_b16 a[138:139], v30 offset:512
    ds_read_b64_tr_b16 a[140:141], v31 offset:0
    ds_read_b64_tr_b16 a[142:143], v31 offset:512
    ds_read_b64_tr_b16 a[144:145], v28 offset:4096
    ds_read_b64_tr_b16 a[146:147], v28 offset:4608
    ds_read_b64_tr_b16 a[148:149], v29 offset:4096
    ds_read_b64_tr_b16 a[150:151], v29 offset:4608
    ds_read_b64_tr_b16 a[152:153], v30 offset:4096
    ds_read_b64_tr_b16 a[154:155], v30 offset:4608
    ds_read_b64_tr_b16 a[156:157], v31 offset:4096
    ds_read_b64_tr_b16 a[158:159], v31 offset:4608
    ds_read_b64_tr_b16 a[160:161], v28 offset:8192
    ds_read_b64_tr_b16 a[162:163], v28 offset:8704
    ds_read_b64_tr_b16 a[164:165], v29 offset:8192
    ds_read_b64_tr_b16 a[166:167], v29 offset:8704
    ds_read_b64_tr_b16 a[168:169], v30 offset:8192
    ds_read_b64_tr_b16 a[170:171], v30 offset:8704
    ds_read_b64_tr_b16 a[172:173], v31 offset:8192
    ds_read_b64_tr_b16 a[174:175], v31 offset:8704
    s_cmp_lt_u32 s46, 7
    s_cselect_b32 s51, 2, 0
    s_mov_b32 s58, 0
    s_lshl_b32 s59, s42, 15
    s_xor_b32 s49, s42, s51
    s_lshl_b32 s49, s49, 15
    s_add_u32 s58, s58, s49
    s_add_u32 s58, s58, 0
    s_and_b32 s65, s43, 3
    s_lshl_b32 s65, s65, 12
    s_mov_b32 s70, 0x40053526
    s_mov_b32 s60, 0
    s_lshl_b32 s50, s46, 13
    s_add_u32 s60, s60, s50
    s_lshl_b32 s50, s42, 11
    s_add_u32 s60, s60, s50
    s_add_u32 s60, s60, 262144
    s_mul_i32 s49, s51, 114688
    s_sub_u32 s0, s60, s49
    s_add_u32 s60, s60, s49
    s_waitcnt vmcnt(5)
    ds_read_b64_tr_b16 a[0:1], v24 offset:0
    ds_read_b64_tr_b16 a[2:3], v24 offset:256
    ds_read_b64_tr_b16 a[4:5], v24 offset:1024
    ds_read_b64_tr_b16 a[6:7], v24 offset:1280
    s_waitcnt vmcnt(3)
    ds_read_b64_tr_b16 a[8:9], v24 offset:2048
    ds_read_b64_tr_b16 a[10:11], v24 offset:2304
    ds_read_b64_tr_b16 a[12:13], v24 offset:3072
    ds_read_b64_tr_b16 a[14:15], v24 offset:3328
    s_waitcnt vmcnt(0)
    v_cmp_ne_u32 vcc, s3, v18
    s_mov_b32 s55, 0
    s_and_b64 vcc, vcc, s[6:7]
    s_cbranch_vccnz L_poll_9
L_poll_9_ok:
    s_waitcnt lgkmcnt(0)
    buffer_load_dwordx4 v[32:35], v237, s[36:39], s57 offen offset:0 sc1
    ds_read_b64_tr_b16 a[176:177], v28 offset:12288
    ds_read_b64_tr_b16 a[178:179], v28 offset:12800
    ds_read_b64_tr_b16 a[180:181], v29 offset:12288
    ds_read_b64_tr_b16 a[182:183], v29 offset:12800
    buffer_load_dwordx4 v[36:39], v237, s[36:39], s57 offen offset:2048 sc1
    ds_read_b64_tr_b16 a[184:185], v30 offset:12288
    ds_read_b64_tr_b16 a[186:187], v30 offset:12800
    ds_read_b64_tr_b16 a[188:189], v31 offset:12288
    ds_read_b64_tr_b16 a[190:191], v31 offset:12800
    s_add_u32 s57, s57, 4096
    buffer_load_dwordx4 v[40:43], v237, s[36:39], s57 offen offset:0 sc1
    ds_read_b64_tr_b16 a[192:193], v28 offset:16384
    ds_read_b64_tr_b16 a[194:195], v28 offset:16896
    ds_read_b64_tr_b16 a[196:197], v29 offset:16384
    ds_read_b64_tr_b16 a[198:199], v29 offset:16896
    buffer_load_dwordx4 v[44:47], v237, s[36:39], s57 offen offset:2048 sc1
    ds_read_b64_tr_b16 a[200:201], v30 offset:16384
    ds_read_b64_tr_b16 a[202:203], v30 offset:16896
    ds_read_b64_tr_b16 a[204:205], v31 offset:16384
    ds_read_b64_tr_b16 a[206:207], v31 offset:16896
    s_add_u32 s57, s57, 4096
    buffer_load_dwordx4 v[48:51], v237, s[36:39], s57 offen offset:0 sc1
    ds_read_b64_tr_b16 a[208:209], v28 offset:20480
    ds_read_b64_tr_b16 a[210:211], v28 offset:20992
    ds_read_b64_tr_b16 a[212:213], v29 offset:20480
    ds_read_b64_tr_b16 a[214:215], v29 offset:20992
    buffer_load_dwordx4 v[52:55], v237, s[36:39], s57 offen offset:2048 sc1
    ds_read_b64_tr_b16 a[216:217], v30 offset:20480
    ds_read_b64_tr_b16 a[218:219], v30 offset:20992
    ds_read_b64_tr_b16 a[220:221], v31 offset:20480
    ds_read_b64_tr_b16 a[222:223], v31 offset:20992
    s_add_u32 s57, s57, 4096
    buffer_load_dwordx4 v[56:59], v237, s[36:39], s57 offen offset:0 sc1
    ds_read_b64_tr_b16 a[224:225], v28 offset:24576
    ds_read_b64_tr_b16 a[226:227], v28 offset:25088
    ds_read_b64_tr_b16 a[228:229], v29 offset:24576
    ds_read_b64_tr_b16 a[230:231], v29 offset:25088
    buffer_load_dwordx4 v[60:63], v237, s[36:39], s57 offen offset:2048 sc1
    ds_read_b64_tr_b16 a[232:233], v30 offset:24576
    ds_read_b64_tr_b16 a[234:235], v30 offset:25088
    ds_read_b64_tr_b16 a[236:237], v31 offset:24576
    ds_read_b64_tr_b16 a[238:239], v31 offset:25088
    s_waitcnt vmcnt(7)
    s_add_u32 s57, s57, 4096
    buffer_load_dwordx4 v[64:67], v237, s[36:39], s57 offen offset:0 sc1
    v_mfma_f32_16x16x32_bf16 v[240:243], a[128:131], v[32:35], v[240:243]
    ds_read_b64_tr_b16 a[240:241], v28 offset:28672
    ds_read_b64_tr_b16 a[242:243], v28 offset:29184
    v_mfma_f32_16x16x32_bf16 v[244:247], a[132:135], v[32:35], v[244:247]
    ds_read_b64_tr_b16 a[244:245], v29 offset:28672
    ds_read_b64_tr_b16 a[246:247], v29 offset:29184
    v_mfma_f32_16x16x32_bf16 v[248:251], a[136:139], v[32:35], v[248:251]
    ds_read_b64_tr_b16 a[248:249], v30 offset:28672
    ds_read_b64_tr_b16 a[250:251], v30 offset:29184
    v_mfma_f32_16x16x32_bf16 v[252:255], a[140:143], v[32:35], v[252:255]
    ds_read_b64_tr_b16 a[252:253], v31 offset:28672
    ds_read_b64_tr_b16 a[254:255], v31 offset:29184
    s_waitcnt vmcnt(7)
    buffer_load_dwordx4 v[68:71], v237, s[36:39], s57 offen offset:2048 sc1
    v_mfma_f32_16x16x32_bf16 v[240:243], a[144:147], v[36:39], v[240:243]
    ds_read_b64_tr_b16 v[96:97], v28 offset:32768
    ds_read_b64_tr_b16 v[98:99], v28 offset:33280
    v_mfma_f32_16x16x32_bf16 v[244:247], a[148:151], v[36:39], v[244:247]
    ds_read_b64_tr_b16 v[100:101], v29 offset:32768
    ds_read_b64_tr_b16 v[102:103], v29 offset:33280
    v_mfma_f32_16x16x32_bf16 v[248:251], a[152:155], v[36:39], v[248:251]
    ds_read_b64_tr_b16 v[104:105], v30 offset:32768
    ds_read_b64_tr_b16 v[106:107], v30 offset:33280
    v_mfma_f32_16x16x32_bf16 v[252:255], a[156:159], v[36:39], v[252:255]
    ds_read_b64_tr_b16 v[108:109], v31 offset:32768
    ds_read_b64_tr_b16 v[110:111], v31 offset:33280
    s_waitcnt vmcnt(7)
    s_add_u32 s57, s57, 4096
    buffer_load_dwordx4 v[72:75], v237, s[36:39], s57 offen offset:0 sc1
    v_mfma_f32_16x16x32_bf16 v[240:243], a[160:163], v[40:43], v[240:243]
    ds_read_b64_tr_b16 v[112:113], v28 offset:36864
    ds_read_b64_tr_b16 v[114:115], v28 offset:37376
    v_mfma_f32_16x16x32_bf16 v[244:247], a[164:167], v[40:43], v[244:247]
    ds_read_b64_tr_b16 v[116:117], v29 offset:36864
    ds_read_b64_tr_b16 v[118:119], v29 offset:37376
    v_mfma_f32_16x16x32_bf16 v[248:251], a[168:171], v[40:43], v[248:251]
    ds_read_b64_tr_b16 v[120:121], v30 offset:36864
    ds_read_b64_tr_b16 v[122:123], v30 offset:37376
    v_mfma_f32_16x16x32_bf16 v[252:255], a[172:175], v[40:43], v[252:255]
    ds_read_b64_tr_b16 v[124:125], v31 offset:36864
    ds_read_b64_tr_b16 v[126:127], v31 offset:37376
    s_waitcnt vmcnt(7)
    s_waitcnt lgkmcnt(15)
    buffer_load_dwordx4 v[76:79], v237, s[36:39], s57 offen offset:2048 sc1
    v_mfma_f32_16x16x32_bf16 v[240:243], a[176:179], v[44:47], v[240:243]
    ds_read_b64_tr_b16 v[128:129], v28 offset:40960
    ds_read_b64_tr_b16 v[130:131], v28 offset:41472
    v_mfma_f32_16x16x32_bf16 v[244:247], a[180:183], v[44:47], v[244:247]
    ds_read_b64_tr_b16 v[132:133], v29 offset:40960
    ds_read_b64_tr_b16 v[134:135], v29 offset:41472
    v_mfma_f32_16x16x32_bf16 v[248:251], a[184:187], v[44:47], v[248:251]
    ds_read_b64_tr_b16 v[136:137], v30 offset:40960
    ds_read_b64_tr_b16 v[138:139], v30 offset:41472
    v_mfma_f32_16x16x32_bf16 v[252:255], a[188:191], v[44:47], v[252:255]
    ds_read_b64_tr_b16 v[140:141], v31 offset:40960
    ds_read_b64_tr_b16 v[142:143], v31 offset:41472
    s_waitcnt vmcnt(7)
    s_add_u32 s57, s57, 4096
    buffer_load_dwordx4 v[80:83], v237, s[36:39], s57 offen offset:0 sc1
    v_mfma_f32_16x16x32_bf16 v[240:243], a[192:195], v[48:51], v[240:243]
    ds_read_b64_tr_b16 v[144:145], v28 offset:45056
    ds_read_b64_tr_b16 v[146:147], v28 offset:45568
    v_mfma_f32_16x16x32_bf16 v[244:247], a[196:199], v[48:51], v[244:247]
    ds_read_b64_tr_b16 v[148:149], v29 offset:45056
    ds_read_b64_tr_b16 v[150:151], v29 offset:45568
    v_mfma_f32_16x16x32_bf16 v[248:251], a[200:203], v[48:51], v[248:251]
    ds_read_b64_tr_b16 v[152:153], v30 offset:45056
    ds_read_b64_tr_b16 v[154:155], v30 offset:45568
    v_mfma_f32_16x16x32_bf16 v[252:255], a[204:207], v[48:51], v[252:255]
    ds_read_b64_tr_b16 v[156:157], v31 offset:45056
    ds_read_b64_tr_b16 v[158:159], v31 offset:45568
    s_waitcnt vmcnt(7)
    buffer_load_dwordx4 v[84:87], v237, s[36:39], s57 offen offset:2048 sc1
    v_mfma_f32_16x16x32_bf16 v[240:243], a[208:211], v[52:55], v[240:243]
    ds_read_b64_tr_b16 v[160:161], v28 offset:49152
    ds_read_b64_tr_b16 v[162:163], v28 offset:49664
    v_mfma_f32_16x16x32_bf16 v[244:247], a[212:215], v[52:55], v[244:247]
    ds_read_b64_tr_b16 v[164:165], v29 offset:49152
    ds_read_b64_tr_b16 v[166:167], v29 offset:49664
    v_mfma_f32_16x16x32_bf16 v[248:251], a[216:219], v[52:55], v[248:251]
    ds_read_b64_tr_b16 v[168:169], v30 offset:49152
    ds_read_b64_tr_b16 v[170:171], v30 offset:49664
    v_mfma_f32_16x16x32_bf16 v[252:255], a[220:223], v[52:55], v[252:255]
    ds_read_b64_tr_b16 v[172:173], v31 offset:49152
    ds_read_b64_tr_b16 v[174:175], v31 offset:49664
    s_waitcnt vmcnt(7)
    s_add_u32 s57, s57, 4096
    buffer_load_dwordx4 v[88:91], v237, s[36:39], s57 offen offset:0 sc1
    v_mfma_f32_16x16x32_bf16 v[240:243], a[224:227], v[56:59], v[240:243]
    ds_read_b64_tr_b16 v[176:177], v28 offset:53248
    ds_read_b64_tr_b16 v[178:179], v28 offset:53760
    v_mfma_f32_16x16x32_bf16 v[244:247], a[228:231], v[56:59], v[244:247]
    ds_read_b64_tr_b16 v[180:181], v29 offset:53248
    ds_read_b64_tr_b16 v[182:183], v29 offset:53760
    v_mfma_f32_16x16x32_bf16 v[248:251], a[232:235], v[56:59], v[248:251]
    ds_read_b64_tr_b16 v[184:185], v30 offset:53248
    ds_read_b64_tr_b16 v[186:187], v30 offset:53760
    v_mfma_f32_16x16x32_bf16 v[252:255], a[236:239], v[56:59], v[252:255]
    ds_read_b64_tr_b16 v[188:189], v31 offset:53248
    ds_read_b64_tr_b16 v[190:191], v31 offset:53760
    s_waitcnt vmcnt(7)
    buffer_load_dwordx4 v[92:95], v237, s[36:39], s57 offen offset:2048 sc1
    v_mfma_f32_16x16x32_bf16 v[240:243], a[240:243], v[60:63], v[240:243]
    ds_read_b64_tr_b16 v[192:193], v28 offset:57344
    ds_read_b64_tr_b16 v[194:195], v28 offset:57856
    v_mfma_f32_16x16x32_bf16 v[244:247], a[244:247], v[60:63], v[244:247]
    ds_read_b64_tr_b16 v[196:197], v29 offset:57344
    ds_read_b64_tr_b16 v[198:199], v29 offset:57856
    v_mfma_f32_16x16x32_bf16 v[248:251], a[248:251], v[60:63], v[248:251]
    ds_read_b64_tr_b16 v[200:201], v30 offset:57344
    ds_read_b64_tr_b16 v[202:203], v30 offset:57856
    v_mfma_f32_16x16x32_bf16 v[252:255], a[252:255], v[60:63], v[252:255]
    ds_read_b64_tr_b16 v[204:205], v31 offset:57344
    ds_read_b64_tr_b16 v[206:207], v31 offset:57856
    s_waitcnt vmcnt(7)
    s_waitcnt lgkmcnt(15)
    v_mfma_f32_16x16x32_bf16 v[240:243], v[96:99], v[64:67], v[240:243]
    ds_read_b64_tr_b16 v[208:209], v28 offset:61440
    ds_read_b64_tr_b16 v[210:211], v28 offset:61952
    v_mfma_f32_16x16x32_bf16 v[244:247], v[100:103], v[64:67], v[244:247]
    ds_read_b64_tr_b16 v[212:213], v29 offset:61440
    ds_read_b64_tr_b16 v[214:215], v29 offset:61952
    v_mfma_f32_16x16x32_bf16 v[248:251], v[104:107], v[64:67], v[248:251]
    ds_read_b64_tr_b16 v[216:217], v30 offset:61440
    ds_read_b64_tr_b16 v[218:219], v30 offset:61952
    v_mfma_f32_16x16x32_bf16 v[252:255], v[108:111], v[64:67], v[252:255]
    ds_read_b64_tr_b16 v[220:221], v31 offset:61440
    ds_read_b64_tr_b16 v[222:223], v31 offset:61952
    s_add_u32 m0, s63, 0
    s_nop 0
    buffer_load_dwordx4 v233, s[20:23], s66 offen lds
    s_waitcnt vmcnt(7)
    v_mfma_f32_16x16x32_bf16 v[240:243], v[112:115], v[68:71], v[240:243]
    v_mfma_f32_16x16x32_bf16 v[244:247], v[116:119], v[68:71], v[244:247]
    v_mfma_f32_16x16x32_bf16 v[248:251], v[120:123], v[68:71], v[248:251]
    v_mfma_f32_16x16x32_bf16 v[252:255], v[124:127], v[68:71], v[252:255]
    s_add_u32 m0, s63, 1024
    s_nop 0
    buffer_load_dwordx4 v233, s[24:27], s66 offen lds
    s_add_u32 s66, s66, 57344
    s_cmp_lt_u32 s66, 917504
    s_cselect_b32 s66, s66, 0
    s_waitcnt vmcnt(7)
    v_mfma_f32_16x16x32_bf16 v[240:243], v[128:131], v[72:75], v[240:243]
    v_mfma_f32_16x16x32_bf16 v[244:247], v[132:135], v[72:75], v[244:247]
    v_mfma_f32_16x16x32_bf16 v[248:251], v[136:139], v[72:75], v[248:251]
    v_mfma_f32_16x16x32_bf16 v[252:255], v[140:143], v[72:75], v[252:255]
    s_add_u32 m0, s63, 2048
    s_nop 0
    buffer_load_dwordx4 v233, s[20:23], s66 offen lds
    s_waitcnt vmcnt(7)
    v_mfma_f32_16x16x32_bf16 v[240:243], v[144:147], v[76:79], v[240:243]
    v_mfma_f32_16x16x32_bf16 v[244:247], v[148:151], v[76:79], v[244:247]
    v_mfma_f32_16x16x32_bf16 v[248:251], v[152:155], v[76:79], v[248:251]
    v_mfma_f32_16x16x32_bf16 v[252:255], v[156:159], v[76:79], v[252:255]
    s_add_u32 m0, s63, 3072
    s_nop 0
    buffer_load_dwordx4 v233, s[24:27], s66 offen lds
    s_add_u32 s66, s66, 57344
    s_cmp_lt_u32 s66, 917504
    s_cselect_b32 s66, s66, 0
    s_waitcnt vmcnt(7)
    v_mfma_f32_16x16x32_bf16 v[240:243], v[160:163], v[80:83], v[240:243]
    v_mfma_f32_16x16x32_bf16 v[244:247], v[164:167], v[80:83], v[244:247]
    v_mfma_f32_16x16x32_bf16 v[248:251], v[168:171], v[80:83], v[248:251]
    v_mfma_f32_16x16x32_bf16 v[252:255], v[172:175], v[80:83], v[252:255]
    s_add_u32 m0, s63, 4096
    s_nop 0
    buffer_load_dwordx4 v233, s[20:23], s66 offen lds
    s_waitcnt vmcnt(7)
    s_waitcnt lgkmcnt(15)
    v_mfma_f32_16x16x32_bf16 v[240:243], v[176:179], v[84:87], v[240:243]
    v_mfma_f32_16x16x32_bf16 v[244:247], v[180:183], v[84:87], v[244:247]
    v_mfma_f32_16x16x32_bf16 v[248:251], v[184:187], v[84:87], v[248:251]
    v_mfma_f32_16x16x32_bf16 v[252:255], v[188:191], v[84:87], v[252:255]
    s_add_u32 m0, s63, 5120
    s_nop 0
    buffer_load_dwordx4 v233, s[24:27], s66 offen lds
    s_add_u32 s66, s66, 57344
    s_cmp_lt_u32 s66, 917504
    s_cselect_b32 s66, s66, 0
    s_waitcnt vmcnt(7)
    s_waitcnt lgkmcnt(8)
    v_mfma_f32_16x16x32_bf16 v[240:243], v[192:195], v[88:91], v[240:243]
    v_mfma_f32_16x16x32_bf16 v[244:247], v[196:199], v[88:91], v[244:247]
    v_mfma_f32_16x16x32_bf16 v[248:251], v[200:203], v[88:91], v[248:251]
    v_mfma_f32_16x16x32_bf16 v[252:255], v[204:207], v[88:91], v[252:255]
    s_add_u32 m0, s63, 6144
    s_nop 0
    buffer_load_dwordx4 v233, s[20:23], s66 offen lds
    s_add_u32 m0, s63, 7168
    s_nop 0
    buffer_load_dwordx4 v233, s[24:27], s66 offen lds
    s_add_u32 s66, s66, 57344
    s_cmp_lt_u32 s66, 917504
    s_cselect_b32 s66, s66, 0
    s_waitcnt vmcnt(8)
    s_waitcnt lgkmcnt(0)
    v_mfma_f32_16x16x32_bf16 v[240:243], v[208:211], v[92:95], v[240:243]
    v_mfma_f32_16x16x32_bf16 v[244:247], v[212:215], v[92:95], v[244:247]
    v_mfma_f32_16x16x32_bf16 v[248:251], v[216:219], v[92:95], v[248:251]
    v_mfma_f32_16x16x32_bf16 v[252:255], v[220:223], v[92:95], v[252:255]
    s_add_u32 m0, s63, 8192
    s_nop 0
    buffer_load_dwordx4 v233, s[20:23], s66 offen lds
    s_add_u32 m0, s63, 9216
    s_nop 0
    buffer_load_dwordx4 v233, s[24:27], s66 offen lds
    s_add_u32 s66, s66, 57344
    s_cmp_lt_u32 s66, 917504
    s_cselect_b32 s66, s66, 0
    v_mov_b32 v34, s3
    v_mov_b32 v35, 0
    s_nop 5
    v_cvt_pk_bf16_f32 v40, v240, v241
    v_cvt_pk_bf16_f32 v41, v242, v243
    v_cvt_pk_bf16_f32 v42, v244, v245
    v_cvt_pk_bf16_f32 v43, v246, v247
    v_cvt_pk_bf16_f32 v44, v248, v249
    v_cvt_pk_bf16_f32 v45, v250, v251
    v_cvt_pk_bf16_f32 v46, v252, v253
    v_cvt_pk_bf16_f32 v47, v254, v255
    v_dot2_f32_bf16 v32, v40, s56, 0
    v_dot2_f32_bf16 v33, v40, v40, 0
    v_dot2_f32_bf16 v36, v41, s56, 0
    v_dot2_f32_bf16 v37, v41, v41, 0
    v_dot2c_f32_bf16 v32, s56, v42
    v_dot2c_f32_bf16 v33, v42, v42
    v_dot2c_f32_bf16 v36, s56, v43
    v_dot2c_f32_bf16 v37, v43, v43
    v_dot2c_f32_bf16 v32, s56, v44
    v_dot2c_f32_bf16 v33, v44, v44
    v_dot2c_f32_bf16 v36, s56, v45
    v_dot2c_f32_bf16 v37, v45, v45
    v_dot2c_f32_bf16 v32, s56, v46
    v_dot2c_f32_bf16 v33, v46, v46
    v_dot2c_f32_bf16 v36, s56, v47
    v_dot2c_f32_bf16 v37, v47, v47
    v_permlane16_swap_b32 v40, v42
    v_permlane16_swap_b32 v41, v43
    v_permlane16_swap_b32 v44, v46
    v_pk_add_f32 v[32:33], v[32:33], v[36:37]
    v_permlane16_swap_b32 v45, v47
    v_mov_b32 v36, v32
    v_mov_b32 v37, v33
    s_nop 0
    v_permlane16_swap_b32 v32, v36
    v_permlane16_swap_b32 v33, v37
    v_pk_add_f32 v[32:33], v[32:33], v[36:37]
    v_mov_b32 v36, v32
    v_mov_b32 v37, v33
    s_nop 0
    v_permlane32_swap_b32 v32, v36
    v_permlane32_swap_b32 v33, v37
    v_pk_add_f32 v[32:33], v[32:33], v[36:37]
    s_mov_b64 exec, 0xffff
    s_cmp_eq_u32 s44, 0
    s_cbranch_scc1 L_slow_10
    buffer_store_dwordx4 v[32:35], v227, s[36:39], s14 offen
L_slow_10_j:
    s_mov_b64 exec, -1
    v_lshlrev_b32 v48, 16, v40
    v_and_b32 v49, 0xffff0000, v40
    v_lshlrev_b32 v50, 16, v41
    v_and_b32 v51, 0xffff0000, v41
    v_lshlrev_b32 v52, 16, v42
    v_and_b32 v53, 0xffff0000, v42
    v_lshlrev_b32 v54, 16, v43
    v_and_b32 v55, 0xffff0000, v43
    v_lshlrev_b32 v56, 16, v44
    v_and_b32 v57, 0xffff0000, v44
    v_lshlrev_b32 v58, 16, v45
    v_and_b32 v59, 0xffff0000, v45
    v_lshlrev_b32 v60, 16, v46
    v_and_b32 v61, 0xffff0000, v46
    v_lshlrev_b32 v62, 16, v47
    v_and_b32 v63, 0xffff0000, v47
    s_cmp_lt_u32 s42, 2
    s_mov_b32 s49, 159744
    s_cselect_b32 s49, 16384, s49
    v_add_u32 v20, s49, v231
    ds_write_b128 v20, v[40:43]
    ds_write_b128 v20, v[44:47] offset:2048
    s_lshr_b32 s51, s46, 3
    s_lshl_b32 s52, s51, 2
    s_add_u32 s52, s52, s42
    s_mul_i32 s67, s52, 229376
    s_lshl_b32 s68, s42, 15
    s_lshl_b32 s69, s42, 13
    s_add_u32 s69, s69, 131072
    s_mul_i32 s50, s52, 14336
    s_add_u32 s50, s50, 262144
    s_mul_i32 s49, s41, 229376
    s_add_u32 s10, s49, s50
    s_add_u32 s11, s10, 114688
    s_xor_b32 s53, s41, 1
    s_mul_i32 s49, s53, 229376
    s_add_u32 s8, s49, s50
    s_add_u32 s9, s8, 114688
    s_mul_i32 s1, s52, 7
    s_xor_b32 s49, s46, 8
    s_lshl_b32 s49, s49, 2
    s_add_u32 s49, s49, s42
    s_mov_b64 s[16:17], 1
    s_lshl_b64 s[16:17], s[16:17], s49
    s_lshl_b32 s49, s40, 12
    s_lshl_b32 s50, s42, 10
    s_add_u32 s49, s49, s50
    s_add_u32 s49, s49, 131072
    s_lshl_b32 s50, s53, 16
    s_add_u32 s18, s49, s50
    s_lshl_b32 s50, s41, 16
    s_add_u32 s19, s49, s50
    s_and_b32 s49, s42, 1
    s_lshl_b32 s49, s49, 5
    v_xor_b32 v4, s49, v224
    v_xor_b32 v5, 64, v4
    v_add_u32 v6, s68, v4
    v_add_u32 v7, s68, v5
    v_add_u32 v8, s69, v4
    v_add_u32 v9, s69, v5
    s_sub_u32 s49, s69, s62
    v_add_u32 v10, s49, v24
    s_lshl_b32 s49, s47, 16
    s_lshl_b32 s50, s40, 7
    s_add_u32 s49, s49, s50
    s_lshl_b32 s50, s42, 5
    s_add_u32 s49, s49, s50
    v_and_b32 v11, 31, v1
    v_lshlrev_b32 v11, 10, v11
    v_lshrrev_b32 v12, 5, v1
    v_lshl_add_u32 v11, v12, 4, v11
    v_add_u32 v11, s49, v11
    v_add_u32 v12, 7168, v226
    v_add_u32 v13, 32768, v227
    s_sub_u32 s49, s68, s62
    v_add_u32 v14, s49, v24
    s_cmp_eq_u32 s42, 3
    s_cselect_b32 s40, 2048, s68
    s_sub_u32 s49, s40, s62
    v_add_u32 v15, s49, v24
    v_add_u32 v27, s40, v4
    v_add_u32 v28, s40, v5
    s_xor_b32 s49, s42, 1
    s_lshl_b32 s49, s49, 15
    s_add_u32 s49, s49, 0
    v_add_u32 v228, s49, v227
    s_xor_b32 s49, s42, 2
    s_lshl_b32 s49, s49, 15
    s_add_u32 s49, s49, 2048
    v_add_u32 v229, s49, v227
    s_xor_b32 s49, s42, 3
    s_lshl_b32 s49, s49, 15
    s_add_u32 s49, s49, 4096
    v_add_u32 v230, s49, v227
    s_mov_b32 s55, 0
L_sg_11:
    buffer_load_dwordx4 v[64:67], v227, s[36:39], s13 offen sc1
    buffer_load_dwordx4 v[68:71], v227, s[36:39], s13 offen offset:1024 sc1
    s_add_u32 s55, s55, 1
    s_cmp_gt_u32 s55, 400000
    s_waitcnt vmcnt(0)
    s_cbranch_scc1 L_sg_11_x
    v_cmp_ne_u32 vcc, s3, v66
    v_cmp_ne_u32 s[52:53], s3, v70
    s_or_b64 vcc, vcc, s[52:53]
    s_cbranch_vccnz L_sg_11
L_sg_11_x:
    v_pk_add_f32 v[64:65], v[64:65], v[68:69]
    ds_read_b64_tr_b16 a[16:17], v24 offset:4096
    ds_read_b64_tr_b16 a[18:19], v24 offset:4352
    ds_read_b64_tr_b16 a[20:21], v24 offset:5120
    ds_read_b64_tr_b16 a[22:23], v24 offset:5376
    ds_read_b64_tr_b16 a[24:25], v25 offset:0
    ds_read_b64_tr_b16 a[26:27], v25 offset:256
    ds_read_b64_tr_b16 a[28:29], v25 offset:1024
    ds_read_b64_tr_b16 a[30:31], v25 offset:1280
    ds_read_b64_tr_b16 a[32:33], v25 offset:2048
    ds_read_b64_tr_b16 a[34:35], v25 offset:2304
    ds_read_b64_tr_b16 a[36:37], v25 offset:3072
    ds_read_b64_tr_b16 a[38:39], v25 offset:3328
    ds_read_b64_tr_b16 a[40:41], v25 offset:4096
    ds_read_b64_tr_b16 a[42:43], v25 offset:4352
    ds_read_b64_tr_b16 a[44:45], v25 offset:5120
    ds_read_b64_tr_b16 a[46:47], v25 offset:5376
    ds_read_b64_tr_b16 a[48:49], v25 offset:6144
    ds_read_b64_tr_b16 a[50:51], v25 offset:6400
    ds_read_b64_tr_b16 a[52:53], v25 offset:7168
    ds_read_b64_tr_b16 a[54:55], v25 offset:7424
    ds_read_b64_tr_b16 a[56:57], v25 offset:8192
    ds_read_b64_tr_b16 a[58:59], v25 offset:8448
    ds_read_b64_tr_b16 a[60:61], v25 offset:9216
    ds_read_b64_tr_b16 a[62:63], v25 offset:9472
    v_mov_b32 v66, v64
    v_mov_b32 v67, v65
    s_nop 0
    v_permlane16_swap_b32 v64, v66
    v_permlane16_swap_b32 v65, v67
    v_pk_add_f32 v[64:65], v[64:65], v[66:67]
    v_mov_b32 v66, v64
    v_mov_b32 v67, v65
    s_nop 0
    v_permlane32_swap_b32 v64, v66
    v_permlane32_swap_b32 v65, v67
    v_pk_add_f32 v[64:65], v[64:65], v[66:67]
    v_mul_f32 v68, 0xbb000000, v64
    v_mul_f32 v69, 0x3b000000, v65
    v_fma_f32 v69, -v68, v68, v69
    v_max_f32 v69, 0, v69
    v_add_f32 v69, 0x3727c5ac, v69
    v_rsq_f32 v69, v69
    s_nop 0
    v_mul_f32 v69, 0x3fb8aa3b, v69
    v_mul_f32 v68, v68, v69
    v_pk_fma_f32 v[48:49], v[48:49], v[68:69], v[68:69] op_sel:[0,1,0] op_sel_hi:[1,1,0]
    v_pk_fma_f32 v[50:51], v[50:51], v[68:69], v[68:69] op_sel:[0,1,0] op_sel_hi:[1,1,0]
    v_pk_fma_f32 v[52:53], v[52:53], v[68:69], v[68:69] op_sel:[0,1,0] op_sel_hi:[1,1,0]
    v_pk_fma_f32 v[54:55], v[54:55], v[68:69], v[68:69] op_sel:[0,1,0] op_sel_hi:[1,1,0]
    v_pk_fma_f32 v[56:57], v[56:57], v[68:69], v[68:69] op_sel:[0,1,0] op_sel_hi:[1,1,0]
    v_pk_fma_f32 v[58:59], v[58:59], v[68:69], v[68:69] op_sel:[0,1,0] op_sel_hi:[1,1,0]
    v_pk_fma_f32 v[60:61], v[60:61], v[68:69], v[68:69] op_sel:[0,1,0] op_sel_hi:[1,1,0]
    v_pk_fma_f32 v[62:63], v[62:63], v[68:69], v[68:69] op_sel:[0,1,0] op_sel_hi:[1,1,0]
    v_cvt_pk_bf16_f32 v72, v48, v49
    v_cvt_pk_bf16_f32 v73, v50, v51
    v_cvt_pk_bf16_f32 v74, v52, v53
    v_cvt_pk_bf16_f32 v75, v54, v55
    v_cvt_pk_bf16_f32 v76, v56, v57
    v_cvt_pk_bf16_f32 v77, v58, v59
    v_cvt_pk_bf16_f32 v78, v60, v61
    v_cvt_pk_bf16_f32 v79, v62, v63
    s_cmp_eq_u32 s44, 0
    s_cbranch_scc1 L_slow_12
    buffer_store_dwordx4 v[72:75], v231, s[36:39], s12 offen
    buffer_store_dwordx4 v[76:79], v231, s[36:39], s12 offen offset:2048
L_slow_12_j:
    s_add_u32 m0, s63, 10240
    s_nop 0
    buffer_load_dwordx4 v233, s[20:23], s66 offen lds
    s_add_u32 m0, s63, 11264
    s_nop 0
    buffer_load_dwordx4 v233, s[24:27], s66 offen lds
    s_add_u32 s66, s66, 57344
    s_cmp_lt_u32 s66, 917504
    s_cselect_b32 s66, s66, 0
    s_add_u32 m0, s64, 0
    s_nop 0
    buffer_load_dwordx4 v233, s[20:23], s66 offen lds
    s_add_u32 m0, s64, 1024
    s_nop 0
    buffer_load_dwordx4 v233, s[24:27], s66 offen lds
    s_add_u32 s66, s66, 57344
    s_cmp_lt_u32 s66, 917504
    s_cselect_b32 s66, s66, 0
    s_add_u32 m0, s64, 2048
    s_nop 0
    buffer_load_dwordx4 v233, s[20:23], s66 offen lds
    s_add_u32 m0, s64, 3072
    s_nop 0
    buffer_load_dwordx4 v233, s[24:27], s66 offen lds
    s_add_u32 s66, s66, 57344
    s_cmp_lt_u32 s66, 917504
    s_cselect_b32 s66, s66, 0
    v_mov_b32 v16, 4096
    v_mov_b32 v17, s3
    s_waitcnt vmcnt(6)
    s_mov_b64 exec, 1
    s_cmp_eq_u32 s44, 0
    s_cbranch_scc1 L_slow_13
    buffer_store_dword v17, v16, s[36:39], s5 offen
L_slow_13_j:
    s_mov_b64 exec, -1
    s_add_u32 s51, s71, 4096
    buffer_load_dword v18, v239, s[36:39], s51 offen sc1
    s_mov_b64 s[6:7], -1
    s_mov_b64 s[14:15], 0x7f
    s_lshl_b64 s[14:15], s[14:15], s1
    s_mov_b32 s12, -1
    s_mov_b32 s13, 0x00ffffff
    v_add_u32 v231, s68, v227
    s_waitcnt vmcnt(6)
    ds_read_b64_tr_b16 a[64:65], v25 offset:10240
    ds_read_b64_tr_b16 a[66:67], v25 offset:10496
    ds_read_b64_tr_b16 a[68:69], v25 offset:11264
    ds_read_b64_tr_b16 a[70:71], v25 offset:11520
    s_waitcnt vmcnt(4)
    ds_read_b64_tr_b16 a[72:73], v26 offset:0
    ds_read_b64_tr_b16 a[74:75], v26 offset:256
    ds_read_b64_tr_b16 a[76:77], v26 offset:1024
    ds_read_b64_tr_b16 a[78:79], v26 offset:1280
    s_waitcnt vmcnt(2)
    ds_read_b64_tr_b16 a[80:81], v26 offset:2048
    ds_read_b64_tr_b16 a[82:83], v26 offset:2304
    ds_read_b64_tr_b16 a[84:85], v26 offset:3072
    ds_read_b64_tr_b16 a[86:87], v26 offset:3328
    s_waitcnt lgkmcnt(0)
    s_barrier
    s_lshl_b32 s49, s42, 10
    v_add_u32 v20, s49, v227
    ds_read_b128 v[248:251], v20 offset:16384
    ds_read_b128 v[252:255], v235
    s_cmp_ge_u32 s46, 14
    s_cbranch_scc1 L_idle3
    s_waitcnt vmcnt(0)
    v_cmp_ne_u32 vcc, s3, v18
    s_mov_b32 s55, 0
    s_and_b64 vcc, vcc, s[6:7]
    s_cbranch_vccnz L_poll_14
L_poll_14_ok:
    s_add_u32 m0, s59, 0
    s_add_u32 s61, s58, s65
    buffer_load_dwordx4 v227, s[36:39], s61 offen offset:0 sc1 lds
    s_add_u32 m0, s59, 0
    s_nop 0
    buffer_load_dwordx4 v227, s[36:39], s61 offen offset:1024 sc1 lds
    s_add_u32 m0, s59, 0
    s_nop 0
    buffer_load_dwordx4 v227, s[36:39], s61 offen offset:2048 sc1 lds
    s_add_u32 m0, s59, 0
    s_nop 0
    buffer_load_dwordx4 v227, s[36:39], s61 offen offset:3072 sc1 lds
    s_add_u32 s65, s65, 4096
    s_and_b32 s65, s65, 16383
    s_add_u32 m0, s59, 4096
    s_add_u32 s61, s58, s65
    buffer_load_dwordx4 v227, s[36:39], s61 offen offset:0 sc1 lds
    s_add_u32 m0, s59, 4096
    s_nop 0
    buffer_load_dwordx4 v227, s[36:39], s61 offen offset:1024 sc1 lds
    s_add_u32 m0, s59, 4096
    s_nop 0
    buffer_load_dwordx4 v227, s[36:39], s61 offen offset:2048 sc1 lds
    s_add_u32 m0, s59, 4096
    s_nop 0
    buffer_load_dwordx4 v227, s[36:39], s61 offen offset:3072 sc1 lds
    s_add_u32 s65, s65, 4096
    s_and_b32 s65, s65, 16383
    s_waitcnt vmcnt(4)
    s_waitcnt lgkmcnt(0)
    s_barrier
    ds_read_b128 v[160:163], v227 offset:0
    ds_read_b128 v[164:167], v227 offset:32768
    ds_read_b128 v[168:171], v236 offset:0
    ds_read_b128 v[172:175], v236 offset:32768
    ds_read_b128 v[176:179], v227 offset:1024
    s_waitcnt lgkmcnt(3)
    v_mfma_f32_32x32x16_bf16 v[32:47], a[0:3], v[160:163], 0
    ds_read_b128 v[180:183], v227 offset:33792
    s_add_u32 m0, s59, 8192
    s_add_u32 s61, s58, s65
    buffer_load_dwordx4 v227, s[36:39], s61 offen offset:0 sc1 lds
    v_mfma_f32_32x32x16_bf16 v[48:63], a[4:7], v[160:163], 0
    s_add_u32 m0, s59, 8192
    s_nop 0
    buffer_load_dwordx4 v227, s[36:39], s61 offen offset:1024 sc1 lds
    v_mfma_f32_32x32x16_bf16 v[64:79], a[0:3], v[164:167], 0
    ds_read_b128 v[184:187], v236 offset:1024
    s_add_u32 m0, s59, 8192
    s_nop 0
    buffer_load_dwordx4 v227, s[36:39], s61 offen offset:2048 sc1 lds
    v_mfma_f32_32x32x16_bf16 v[80:95], a[4:7], v[164:167], 0
    s_add_u32 m0, s59, 8192
    s_nop 0
    buffer_load_dwordx4 v227, s[36:39], s61 offen offset:3072 sc1 lds
    s_add_u32 s65, s65, 4096
    s_and_b32 s65, s65, 16383
    s_waitcnt lgkmcnt(3)
    v_mfma_f32_32x32x16_bf16 v[96:111], a[0:3], v[168:171], 0
    ds_read_b128 v[188:191], v236 offset:33792
    s_add_u32 m0, s68, 20480
    s_nop 0
    buffer_load_dwordx4 v233, s[20:23], s66 offen lds
    s_add_u32 m0, s68, 21504
    v_mfma_f32_32x32x16_bf16 v[112:127], a[4:7], v[168:171], 0
    buffer_load_dwordx4 v233, s[24:27], s66 offen lds
    s_add_u32 s66, s66, 57344
    s_cmp_lt_u32 s66, 917504
    s_cselect_b32 s66, s66, 0
    v_mfma_f32_32x32x16_bf16 v[128:143], a[0:3], v[172:175], 0
    ds_read_b128 v[160:163], v227 offset:2048
    s_add_u32 m0, s68, 22528
    s_nop 0
    buffer_load_dwordx4 v233, s[20:23], s66 offen lds
    s_add_u32 m0, s68, 23552
    v_mfma_f32_32x32x16_bf16 v[144:159], a[4:7], v[172:175], 0
    buffer_load_dwordx4 v233, s[24:27], s66 offen lds
    s_add_u32 s66, s66, 57344
    s_cmp_lt_u32 s66, 917504
    s_cselect_b32 s66, s66, 0
    s_waitcnt lgkmcnt(3)
    v_mfma_f32_32x32x16_bf16 v[32:47], a[8:11], v[176:179], v[32:47]
    ds_read_b128 v[164:167], v227 offset:34816
    v_mfma_f32_32x32x16_bf16 v[48:63], a[12:15], v[176:179], v[48:63]
    v_mfma_f32_32x32x16_bf16 v[64:79], a[8:11], v[180:183], v[64:79]
    ds_read_b128 v[168:171], v236 offset:2048
    v_mfma_f32_32x32x16_bf16 v[80:95], a[12:15], v[180:183], v[80:95]
    s_waitcnt lgkmcnt(3)
    v_mfma_f32_32x32x16_bf16 v[96:111], a[8:11], v[184:187], v[96:111]
    ds_read_b128 v[172:175], v236 offset:34816
    s_add_u32 m0, s68, 24576
    s_nop 0
    buffer_load_dwordx4 v233, s[20:23], s66 offen lds
    s_add_u32 m0, s68, 25600
    v_mfma_f32_32x32x16_bf16 v[112:127], a[12:15], v[184:187], v[112:127]
    buffer_load_dwordx4 v233, s[24:27], s66 offen lds
    s_add_u32 s66, s66, 57344
    s_cmp_lt_u32 s66, 917504
    s_cselect_b32 s66, s66, 0
    v_mfma_f32_32x32x16_bf16 v[128:143], a[8:11], v[188:191], v[128:143]
    ds_read_b128 v[176:179], v227 offset:3072
    v_mfma_f32_32x32x16_bf16 v[144:159], a[12:15], v[188:191], v[144:159]
    s_waitcnt lgkmcnt(3)
    v_mfma_f32_32x32x16_bf16 v[32:47], a[16:19], v[160:163], v[32:47]
    ds_read_b128 v[180:183], v227 offset:35840
    s_add_u32 m0, s68, 26624
    s_nop 0
    buffer_load_dwordx4 v233, s[20:23], s66 offen lds
    s_add_u32 m0, s68, 27648
    v_mfma_f32_32x32x16_bf16 v[48:63], a[20:23], v[160:163], v[48:63]
    buffer_load_dwordx4 v233, s[24:27], s66 offen lds
    s_add_u32 s66, s66, 57344
    s_cmp_lt_u32 s66, 917504
    s_cselect_b32 s66, s66, 0
    v_mfma_f32_32x32x16_bf16 v[64:79], a[16:19], v[164:167], v[64:79]
    ds_read_b128 v[184:187], v236 offset:3072
    v_mfma_f32_32x32x16_bf16 v[80:95], a[20:23], v[164:167], v[80:95]
    s_waitcnt lgkmcnt(3)
    v_mfma_f32_32x32x16_bf16 v[96:111], a[16:19], v[168:171], v[96:111]
    ds_read_b128 v[188:191], v236 offset:35840
    s_add_u32 m0, s68, 28672
    s_nop 0
    buffer_load_dwordx4 v233, s[20:23], s66 offen lds
    s_add_u32 m0, s68, 29696
    v_mfma_f32_32x32x16_bf16 v[112:127], a[20:23], v[168:171], v[112:127]
    buffer_load_dwordx4 v233, s[24:27], s66 offen lds
    s_add_u32 s66, s66, 57344
    s_cmp_lt_u32 s66, 917504
    s_cselect_b32 s66, s66, 0
    s_add_u32 s66, s66, 917504
    s_waitcnt vmcnt(14)
    s_barrier
    v_mfma_f32_32x32x16_bf16 v[128:143], a[16:19], v[172:175], v[128:143]
    ds_read_b128 v[160:163], v227 offset:4096
    v_mfma_f32_32x32x16_bf16 v[144:159], a[20:23], v[172:175], v[144:159]
    s_waitcnt lgkmcnt(3)
    v_mfma_f32_32x32x16_bf16 v[32:47], a[24:27], v[176:179], v[32:47]
    ds_read_b128 v[164:167], v227 offset:36864
    s_add_u32 m0, s59, 12288
    s_add_u32 s61, s58, s65
    buffer_load_dwordx4 v227, s[36:39], s61 offen offset:0 sc1 lds
    v_mfma_f32_32x32x16_bf16 v[48:63], a[28:31], v[176:179], v[48:63]
    s_add_u32 m0, s59, 12288
    s_nop 0
    buffer_load_dwordx4 v227, s[36:39], s61 offen offset:1024 sc1 lds
    v_mfma_f32_32x32x16_bf16 v[64:79], a[24:27], v[180:183], v[64:79]
    ds_read_b128 v[168:171], v236 offset:4096
    s_add_u32 m0, s59, 12288
    s_nop 0
    buffer_load_dwordx4 v227, s[36:39], s61 offen offset:2048 sc1 lds
    v_mfma_f32_32x32x16_bf16 v[80:95], a[28:31], v[180:183], v[80:95]
    s_add_u32 m0, s59, 12288
    s_nop 0
    buffer_load_dwordx4 v227, s[36:39], s61 offen offset:3072 sc1 lds
    s_add_u32 s65, s65, 4096
    s_and_b32 s65, s65, 16383
    s_add_u32 s58, s58, 16384
    s_waitcnt lgkmcnt(3)
    v_mfma_f32_32x32x16_bf16 v[96:111], a[24:27], v[184:187], v[96:111]
    ds_read_b128 v[172:175], v236 offset:36864
    v_mfma_f32_32x32x16_bf16 v[112:127], a[28:31], v[184:187], v[112:127]
    v_mfma_f32_32x32x16_bf16 v[128:143], a[24:27], v[188:191], v[128:143]
    ds_read_b128 v[176:179], v227 offset:5120
    v_mfma_f32_32x32x16_bf16 v[144:159], a[28:31], v[188:191], v[144:159]
    s_waitcnt lgkmcnt(3)
    v_mfma_f32_32x32x16_bf16 v[32:47], a[32:35], v[160:163], v[32:47]
    ds_read_b128 v[180:183], v227 offset:37888
    v_mfma_f32_32x32x16_bf16 v[48:63], a[36:39], v[160:163], v[48:63]
    v_mfma_f32_32x32x16_bf16 v[64:79], a[32:35], v[164:167], v[64:79]
    ds_read_b128 v[184:187], v236 offset:5120
    v_mfma_f32_32x32x16_bf16 v[80:95], a[36:39], v[164:167], v[80:95]
    s_waitcnt lgkmcnt(3)
    v_mfma_f32_32x32x16_bf16 v[96:111], a[32:35], v[168:171], v[96:111]
    ds_read_b128 v[188:191], v236 offset:37888
    s_add_u32 m0, s59, 16384
    s_add_u32 s61, s58, s65
    buffer_load_dwordx4 v227, s[36:39], s61 offen offset:0 sc1 lds
    v_mfma_f32_32x32x16_bf16 v[112:127], a[36:39], v[168:171], v[112:127]
    s_waitcnt vmcnt(13)
    ds_read_b64_tr_b16 a[88:89], v14 offset:20480
    ds_read_b64_tr_b16 a[90:91], v14 offset:20736
    ds_read_b64_tr_b16 a[92:93], v14 offset:21504
    ds_read_b64_tr_b16 a[94:95], v14 offset:21760
    s_add_u32 m0, s59, 16384
    s_nop 0
    buffer_load_dwordx4 v227, s[36:39], s61 offen offset:1024 sc1 lds
    v_mfma_f32_32x32x16_bf16 v[128:143], a[32:35], v[172:175], v[128:143]
    ds_read_b128 v[160:163], v227 offset:6144
    s_add_u32 m0, s59, 16384
    s_nop 0
    buffer_load_dwordx4 v227, s[36:39], s61 offen offset:2048 sc1 lds
    v_mfma_f32_32x32x16_bf16 v[144:159], a[36:39], v[172:175], v[144:159]
    s_waitcnt vmcnt(13)
    ds_read_b64_tr_b16 a[96:97], v14 offset:22528
    ds_read_b64_tr_b16 a[98:99], v14 offset:22784
    ds_read_b64_tr_b16 a[100:101], v14 offset:23552
    ds_read_b64_tr_b16 a[102:103], v14 offset:23808
    s_add_u32 m0, s59, 16384
    s_nop 0
    buffer_load_dwordx4 v227, s[36:39], s61 offen offset:3072 sc1 lds
    s_add_u32 s65, s65, 4096
    s_and_b32 s65, s65, 16383
    s_waitcnt lgkmcnt(11)
    v_mfma_f32_32x32x16_bf16 v[32:47], a[40:43], v[176:179], v[32:47]
    ds_read_b128 v[164:167], v227 offset:38912
    s_add_u32 m0, s69, 0
    s_nop 0
    buffer_load_dwordx4 v233, s[20:23], s66 offen lds
    s_add_u32 m0, s69, 1024
    v_mfma_f32_32x32x16_bf16 v[48:63], a[44:47], v[176:179], v[48:63]
    buffer_load_dwordx4 v233, s[24:27], s66 offen lds
    s_add_u32 s66, s66, 57344
    s_cmp_lt_u32 s66, 1835008
    s_cselect_b32 s66, s66, 917504
    v_mfma_f32_32x32x16_bf16 v[64:79], a[40:43], v[180:183], v[64:79]
    ds_read_b128 v[168:171], v236 offset:6144
    s_add_u32 m0, s69, 2048
    s_nop 0
    buffer_load_dwordx4 v233, s[20:23], s66 offen lds
    s_add_u32 m0, s69, 3072
    v_mfma_f32_32x32x16_bf16 v[80:95], a[44:47], v[180:183], v[80:95]
    buffer_load_dwordx4 v233, s[24:27], s66 offen lds
    s_add_u32 s66, s66, 57344
    s_cmp_lt_u32 s66, 1835008
    s_cselect_b32 s66, s66, 917504
    s_waitcnt lgkmcnt(11)
    v_mfma_f32_32x32x16_bf16 v[96:111], a[40:43], v[184:187], v[96:111]
    ds_read_b128 v[172:175], v236 offset:38912
    v_mfma_f32_32x32x16_bf16 v[112:127], a[44:47], v[184:187], v[112:127]
    s_waitcnt vmcnt(16)
    ds_read_b64_tr_b16 a[104:105], v14 offset:24576
    ds_read_b64_tr_b16 a[106:107], v14 offset:24832
    ds_read_b64_tr_b16 a[108:109], v14 offset:25600
    ds_read_b64_tr_b16 a[110:111], v14 offset:25856
    v_mfma_f32_32x32x16_bf16 v[128:143], a[40:43], v[188:191], v[128:143]
    ds_read_b128 v[176:179], v227 offset:7168
    v_mfma_f32_32x32x16_bf16 v[144:159], a[44:47], v[188:191], v[144:159]
    s_waitcnt lgkmcnt(7)
    v_mfma_f32_32x32x16_bf16 v[32:47], a[48:51], v[160:163], v[32:47]
    ds_read_b128 v[180:183], v227 offset:39936
    s_add_u32 m0, s59, 20480
    s_add_u32 s61, s58, s65
    buffer_load_dwordx4 v227, s[36:39], s61 offen offset:0 sc1 lds
    v_mfma_f32_32x32x16_bf16 v[48:63], a[52:55], v[160:163], v[48:63]
    s_waitcnt vmcnt(15)
    ds_read_b64_tr_b16 a[112:113], v14 offset:26624
    ds_read_b64_tr_b16 a[114:115], v14 offset:26880
    ds_read_b64_tr_b16 a[116:117], v14 offset:27648
    ds_read_b64_tr_b16 a[118:119], v14 offset:27904
    s_add_u32 m0, s59, 20480
    s_nop 0
    buffer_load_dwordx4 v227, s[36:39], s61 offen offset:1024 sc1 lds
    v_mfma_f32_32x32x16_bf16 v[64:79], a[48:51], v[164:167], v[64:79]
    ds_read_b128 v[184:187], v236 offset:7168
    s_add_u32 m0, s59, 20480
    s_nop 0
    buffer_load_dwordx4 v227, s[36:39], s61 offen offset:2048 sc1 lds
    v_mfma_f32_32x32x16_bf16 v[80:95], a[52:55], v[164:167], v[80:95]
    s_add_u32 m0, s59, 20480
    s_nop 0
    buffer_load_dwordx4 v227, s[36:39], s61 offen offset:3072 sc1 lds
    s_add_u32 s65, s65, 4096
    s_and_b32 s65, s65, 16383
    s_waitcnt lgkmcnt(11)
    v_mfma_f32_32x32x16_bf16 v[96:111], a[48:51], v[168:171], v[96:111]
    ds_read_b128 v[188:191], v236 offset:39936
    s_add_u32 m0, s69, 4096
    s_nop 0
    buffer_load_dwordx4 v233, s[20:23], s66 offen lds
    s_add_u32 m0, s69, 5120
    v_mfma_f32_32x32x16_bf16 v[112:127], a[52:55], v[168:171], v[112:127]
    s_waitcnt vmcnt(17)
    ds_read_b64_tr_b16 a[120:121], v14 offset:28672
    ds_read_b64_tr_b16 a[122:123], v14 offset:28928
    ds_read_b64_tr_b16 a[124:125], v14 offset:29696
    ds_read_b64_tr_b16 a[126:127], v14 offset:29952
    buffer_load_dwordx4 v233, s[24:27], s66 offen lds
    s_add_u32 s66, s66, 57344
    s_cmp_lt_u32 s66, 1835008
    s_cselect_b32 s66, s66, 917504
    s_barrier
    v_mfma_f32_32x32x16_bf16 v[128:143], a[48:51], v[172:175], v[128:143]
    ds_read_b128 v[160:163], v227 offset:8192
    s_add_u32 m0, s69, 6144
    s_nop 0
    buffer_load_dwordx4 v233, s[20:23], s66 offen lds
    s_add_u32 m0, s69, 7168
    v_mfma_f32_32x32x16_bf16 v[144:159], a[52:55], v[172:175], v[144:159]
    buffer_load_dwordx4 v233, s[24:27], s66 offen lds
    s_add_u32 s66, s66, 57344
    s_cmp_lt_u32 s66, 1835008
    s_cselect_b32 s66, s66, 917504
    s_waitcnt lgkmcnt(11)
    v_mfma_f32_32x32x16_bf16 v[32:47], a[56:59], v[176:179], v[32:47]
    ds_read_b128 v[164:167], v227 offset:40960
    v_mfma_f32_32x32x16_bf16 v[48:63], a[60:63], v[176:179], v[48:63]
    v_mfma_f32_32x32x16_bf16 v[64:79], a[56:59], v[180:183], v[64:79]
    ds_read_b128 v[168:171], v236 offset:8192
    v_mfma_f32_32x32x16_bf16 v[80:95], a[60:63], v[180:183], v[80:95]
    s_waitcnt lgkmcnt(7)
    v_mfma_f32_32x32x16_bf16 v[96:111], a[56:59], v[184:187], v[96:111]
    ds_read_b128 v[172:175], v236 offset:40960
    s_add_u32 m0, s59, 24576
    s_add_u32 s61, s58, s65
    buffer_load_dwordx4 v227, s[36:39], s61 offen offset:0 sc1 lds
    v_mfma_f32_32x32x16_bf16 v[112:127], a[60:63], v[184:187], v[112:127]
    s_add_u32 m0, s59, 24576
    s_nop 0
    buffer_load_dwordx4 v227, s[36:39], s61 offen offset:1024 sc1 lds
    v_mfma_f32_32x32x16_bf16 v[128:143], a[56:59], v[188:191], v[128:143]
    ds_read_b128 v[176:179], v227 offset:9216
    s_add_u32 m0, s59, 24576
    s_nop 0
    buffer_load_dwordx4 v227, s[36:39], s61 offen offset:2048 sc1 lds
    v_mfma_f32_32x32x16_bf16 v[144:159], a[60:63], v[188:191], v[144:159]
    s_add_u32 m0, s59, 24576
    s_nop 0
    buffer_load_dwordx4 v227, s[36:39], s61 offen offset:3072 sc1 lds
    s_add_u32 s65, s65, 4096
    s_and_b32 s65, s65, 16383
    s_waitcnt lgkmcnt(3)
    v_mfma_f32_32x32x16_bf16 v[32:47], a[64:67], v[160:163], v[32:47]
    ds_read_b128 v[180:183], v227 offset:41984
    s_add_u32 m0, s68, 0
    s_nop 0
    buffer_load_dwordx4 v233, s[20:23], s66 offen lds
    s_add_u32 m0, s68, 1024
    v_mfma_f32_32x32x16_bf16 v[48:63], a[68:71], v[160:163], v[48:63]
    buffer_load_dwordx4 v233, s[24:27], s66 offen lds
    s_add_u32 s66, s66, 57344
    s_cmp_lt_u32 s66, 1835008
    s_cselect_b32 s66, s66, 917504
    v_mfma_f32_32x32x16_bf16 v[64:79], a[64:67], v[164:167], v[64:79]
    ds_read_b128 v[184:187], v236 offset:9216
    s_add_u32 m0, s68, 2048
    s_nop 0
    buffer_load_dwordx4 v233, s[20:23], s66 offen lds
    s_add_u32 m0, s68, 3072
    v_mfma_f32_32x32x16_bf16 v[80:95], a[68:71], v[164:167], v[80:95]
    buffer_load_dwordx4 v233, s[24:27], s66 offen lds
    s_add_u32 s66, s66, 57344
    s_cmp_lt_u32 s66, 1835008
    s_cselect_b32 s66, s66, 917504
    s_waitcnt lgkmcnt(3)
    v_mfma_f32_32x32x16_bf16 v[96:111], a[64:67], v[168:171], v[96:111]
    ds_read_b128 v[188:191], v236 offset:41984
    v_mfma_f32_32x32x16_bf16 v[112:127], a[68:71], v[168:171], v[112:127]
    v_mfma_f32_32x32x16_bf16 v[128:143], a[64:67], v[172:175], v[128:143]
    ds_read_b128 v[160:163], v227 offset:10240
    v_mfma_f32_32x32x16_bf16 v[144:159], a[68:71], v[172:175], v[144:159]
    s_waitcnt lgkmcnt(3)
    v_mfma_f32_32x32x16_bf16 v[32:47], a[72:75], v[176:179], v[32:47]
    ds_read_b128 v[164:167], v227 offset:43008
    s_add_u32 m0, s59, 28672
    s_add_u32 s61, s58, s65
    buffer_load_dwordx4 v227, s[36:39], s61 offen offset:0 sc1 lds
    v_mfma_f32_32x32x16_bf16 v[48:63], a[76:79], v[176:179], v[48:63]
    s_waitcnt vmcnt(19)
    ds_read_b64_tr_b16 a[128:129], v10 offset:0
    ds_read_b64_tr_b16 a[130:131], v10 offset:256
    ds_read_b64_tr_b16 a[132:133], v10 offset:1024
    ds_read_b64_tr_b16 a[134:135], v10 offset:1280
    s_add_u32 m0, s59, 28672
    s_nop 0
    buffer_load_dwordx4 v227, s[36:39], s61 offen offset:1024 sc1 lds
    v_mfma_f32_32x32x16_bf16 v[64:79], a[72:75], v[180:183], v[64:79]
    ds_read_b128 v[168:171], v236 offset:10240
    s_add_u32 m0, s59, 28672
    s_nop 0
    buffer_load_dwordx4 v227, s[36:39], s61 offen offset:2048 sc1 lds
    v_mfma_f32_32x32x16_bf16 v[80:95], a[76:79], v[180:183], v[80:95]
    s_waitcnt vmcnt(19)
    ds_read_b64_tr_b16 a[136:137], v10 offset:2048
    ds_read_b64_tr_b16 a[138:139], v10 offset:2304
    ds_read_b64_tr_b16 a[140:141], v10 offset:3072
    ds_read_b64_tr_b16 a[142:143], v10 offset:3328
    s_add_u32 m0, s59, 28672
    s_nop 0
    buffer_load_dwordx4 v227, s[36:39], s61 offen offset:3072 sc1 lds
    s_add_u32 s65, s65, 4096
    s_and_b32 s65, s65, 16383
    s_waitcnt lgkmcnt(11)
    v_mfma_f32_32x32x16_bf16 v[96:111], a[72:75], v[184:187], v[96:111]
    ds_read_b128 v[172:175], v236 offset:43008
    s_waitcnt lgkmcnt(6)
    s_add_u32 m0, s69, 0
    s_nop 0
    buffer_load_dwordx4 v233, s[20:23], s66 offen lds
    s_add_u32 m0, s69, 1024
    v_mfma_f32_32x32x16_bf16 v[112:127], a[76:79], v[184:187], v[112:127]
    buffer_load_dwordx4 v233, s[24:27], s66 offen lds
    s_add_u32 s66, s66, 57344
    s_cmp_lt_u32 s66, 1835008
    s_cselect_b32 s66, s66, 917504
    v_mfma_f32_32x32x16_bf16 v[128:143], a[72:75], v[188:191], v[128:143]
    ds_read_b128 v[176:179], v227 offset:11264
    s_waitcnt lgkmcnt(2)
    s_add_u32 m0, s69, 2048
    s_nop 0
    buffer_load_dwordx4 v233, s[20:23], s66 offen lds
    s_add_u32 m0, s69, 3072
    v_mfma_f32_32x32x16_bf16 v[144:159], a[76:79], v[188:191], v[144:159]
    buffer_load_dwordx4 v233, s[24:27], s66 offen lds
    s_add_u32 s66, s66, 57344
    s_cmp_lt_u32 s66, 1835008
    s_cselect_b32 s66, s66, 917504
    v_mfma_f32_32x32x16_bf16 v[32:47], a[80:83], v[160:163], v[32:47]
    ds_read_b128 v[180:183], v227 offset:44032
    v_mfma_f32_32x32x16_bf16 v[48:63], a[84:87], v[160:163], v[48:63]
    v_mfma_f32_32x32x16_bf16 v[64:79], a[80:83], v[164:167], v[64:79]
    ds_read_b128 v[184:187], v236 offset:11264
    v_mfma_f32_32x32x16_bf16 v[80:95], a[84:87], v[164:167], v[80:95]
    s_waitcnt lgkmcnt(3)
    v_mfma_f32_32x32x16_bf16 v[96:111], a[80:83], v[168:171], v[96:111]
    ds_read_b128 v[188:191], v236 offset:44032
    v_mfma_f32_32x32x16_bf16 v[112:127], a[84:87], v[168:171], v[112:127]
    s_waitcnt vmcnt(18)
    ds_read_b64_tr_b16 a[144:145], v10 offset:4096
    ds_read_b64_tr_b16 a[146:147], v10 offset:4352
    ds_read_b64_tr_b16 a[148:149], v10 offset:5120
    ds_read_b64_tr_b16 a[150:151], v10 offset:5376
    s_barrier
    v_mfma_f32_32x32x16_bf16 v[128:143], a[80:83], v[172:175], v[128:143]
    ds_read_b128 v[160:163], v227 offset:12288
    v_mfma_f32_32x32x16_bf16 v[144:159], a[84:87], v[172:175], v[144:159]
    s_waitcnt vmcnt(16)
    ds_read_b64_tr_b16 a[152:153], v10 offset:6144
    ds_read_b64_tr_b16 a[154:155], v10 offset:6400
    ds_read_b64_tr_b16 a[156:157], v10 offset:7168
    ds_read_b64_tr_b16 a[158:159], v10 offset:7424
    s_waitcnt lgkmcnt(11)
    v_mfma_f32_32x32x16_bf16 v[32:47], a[88:91], v[176:179], v[32:47]
    ds_read_b128 v[164:167], v227 offset:45056
    s_waitcnt lgkmcnt(6)
    s_add_u32 m0, s69, 4096
    s_nop 0
    buffer_load_dwordx4 v233, s[20:23], s66 offen lds
    s_add_u32 m0, s69, 5120
    v_mfma_f32_32x32x16_bf16 v[48:63], a[92:95], v[176:179], v[48:63]
    buffer_load_dwordx4 v233, s[24:27], s66 offen lds
    s_add_u32 s66, s66, 57344
    s_cmp_lt_u32 s66, 1835008
    s_cselect_b32 s66, s66, 917504
    v_mfma_f32_32x32x16_bf16 v[64:79], a[88:91], v[180:183], v[64:79]
    ds_read_b128 v[168:171], v236 offset:12288
    s_add_u32 m0, s68, 4096
    s_nop 0
    buffer_load_dwordx4 v233, s[20:23], s66 offen lds
    s_add_u32 m0, s68, 5120
    v_mfma_f32_32x32x16_bf16 v[80:95], a[92:95], v[180:183], v[80:95]
    buffer_load_dwordx4 v233, s[24:27], s66 offen lds
    s_add_u32 s66, s66, 57344
    s_cmp_lt_u32 s66, 1835008
    s_cselect_b32 s66, s66, 917504
    v_mfma_f32_32x32x16_bf16 v[96:111], a[88:91], v[184:187], v[96:111]
    ds_read_b128 v[172:175], v236 offset:45056
    v_mfma_f32_32x32x16_bf16 v[112:127], a[92:95], v[184:187], v[112:127]
    v_mfma_f32_32x32x16_bf16 v[128:143], a[88:91], v[188:191], v[128:143]
    ds_read_b128 v[176:179], v227 offset:13312
    v_mfma_f32_32x32x16_bf16 v[144:159], a[92:95], v[188:191], v[144:159]
    s_waitcnt lgkmcnt(3)
    v_mfma_f32_32x32x16_bf16 v[32:47], a[96:99], v[160:163], v[32:47]
    ds_read_b128 v[180:183], v227 offset:46080
    s_add_u32 m0, s68, 6144
    s_nop 0
    buffer_load_dwordx4 v233, s[20:23], s66 offen lds
    s_add_u32 m0, s68, 7168
    v_mfma_f32_32x32x16_bf16 v[48:63], a[100:103], v[160:163], v[48:63]
    s_waitcnt vmcnt(15)
    ds_read_b64_tr_b16 a[160:161], v14 offset:0
    ds_read_b64_tr_b16 a[162:163], v14 offset:256
    ds_read_b64_tr_b16 a[164:165], v14 offset:1024
    ds_read_b64_tr_b16 a[166:167], v14 offset:1280
    buffer_load_dwordx4 v233, s[24:27], s66 offen lds
    s_add_u32 s66, s66, 57344
    s_cmp_lt_u32 s66, 1835008
    s_cselect_b32 s66, s66, 917504
    v_mfma_f32_32x32x16_bf16 v[64:79], a[96:99], v[164:167], v[64:79]
    ds_read_b128 v[184:187], v236 offset:13312
    v_mfma_f32_32x32x16_bf16 v[80:95], a[100:103], v[164:167], v[80:95]
    s_waitcnt vmcnt(14)
    ds_read_b64_tr_b16 a[168:169], v14 offset:2048
    ds_read_b64_tr_b16 a[170:171], v14 offset:2304
    ds_read_b64_tr_b16 a[172:173], v14 offset:3072
    ds_read_b64_tr_b16 a[174:175], v14 offset:3328
    s_waitcnt lgkmcnt(11)
    v_mfma_f32_32x32x16_bf16 v[96:111], a[96:99], v[168:171], v[96:111]
    ds_read_b128 v[188:191], v227 offset:14336
    s_add_u32 m0, s69, 6144
    s_nop 0
    buffer_load_dwordx4 v233, s[20:23], s66 offen lds
    s_add_u32 m0, s69, 7168
    v_mfma_f32_32x32x16_bf16 v[112:127], a[100:103], v[168:171], v[112:127]
    buffer_load_dwordx4 v233, s[24:27], s66 offen lds
    s_add_u32 s66, s66, 57344
    s_cmp_lt_u32 s66, 1835008
    s_cselect_b32 s66, s66, 917504
    v_mfma_f32_32x32x16_bf16 v[128:143], a[96:99], v[172:175], v[128:143]
    ds_read_b128 v[160:163], v227 offset:47104
    v_mfma_f32_32x32x16_bf16 v[144:159], a[100:103], v[172:175], v[144:159]
    s_waitcnt lgkmcnt(11)
    v_mfma_f32_32x32x16_bf16 v[32:47], a[104:107], v[176:179], v[32:47]
    ds_read_b128 v[164:167], v236 offset:14336
    s_waitcnt lgkmcnt(8)
    s_add_u32 m0, s68, 0
    s_nop 0
    buffer_load_dwordx4 v233, s[20:23], s66 offen lds
    s_add_u32 m0, s68, 1024
    v_mfma_f32_32x32x16_bf16 v[48:63], a[108:111], v[176:179], v[48:63]
    buffer_load_dwordx4 v233, s[24:27], s66 offen lds
    s_add_u32 s66, s66, 57344
    s_cmp_lt_u32 s66, 1835008
    s_cselect_b32 s66, s66, 917504
    v_mfma_f32_32x32x16_bf16 v[64:79], a[104:107], v[180:183], v[64:79]
    ds_read_b128 v[168:171], v227 offset:15360
    v_mfma_f32_32x32x16_bf16 v[80:95], a[108:111], v[180:183], v[80:95]
    s_waitcnt lgkmcnt(3)
    v_mfma_f32_32x32x16_bf16 v[96:111], a[104:107], v[184:187], v[96:111]
    ds_read_b128 v[172:175], v227 offset:48128
    s_add_u32 m0, s68, 2048
    s_nop 0
    buffer_load_dwordx4 v233, s[20:23], s66 offen lds
    s_add_u32 m0, s68, 3072
    v_mfma_f32_32x32x16_bf16 v[112:127], a[108:111], v[184:187], v[112:127]
    s_waitcnt vmcnt(13)
    ds_read_b64_tr_b16 a[176:177], v10 offset:0
    ds_read_b64_tr_b16 a[178:179], v10 offset:256
    ds_read_b64_tr_b16 a[180:181], v10 offset:1024
    ds_read_b64_tr_b16 a[182:183], v10 offset:1280
    buffer_load_dwordx4 v233, s[24:27], s66 offen lds
    s_add_u32 s66, s66, 57344
    s_cmp_lt_u32 s66, 1835008
    s_cselect_b32 s66, s66, 917504
    v_mfma_f32_32x32x16_bf16 v[32:47], a[112:115], v[188:191], v[32:47]
    ds_read_b128 v[176:179], v236 offset:15360
    v_mfma_f32_32x32x16_bf16 v[48:63], a[116:119], v[188:191], v[48:63]
    s_waitcnt vmcnt(12)
    ds_read_b64_tr_b16 a[184:185], v10 offset:2048
    ds_read_b64_tr_b16 a[186:187], v10 offset:2304
    ds_read_b64_tr_b16 a[188:189], v10 offset:3072
    ds_read_b64_tr_b16 a[190:191], v10 offset:3328
    s_barrier
    s_waitcnt lgkmcnt(11)
    v_mfma_f32_32x32x16_bf16 v[64:79], a[112:115], v[160:163], v[64:79]
    ds_read_b128 v[180:183], v227 offset:16384
    v_mfma_f32_32x32x16_bf16 v[80:95], a[116:119], v[160:163], v[80:95]
    v_mfma_f32_32x32x16_bf16 v[96:111], a[112:115], v[164:167], v[96:111]
    ds_read_b128 v[184:187], v227 offset:49152
    s_waitcnt lgkmcnt(7)
    s_add_u32 m0, s69, 0
    s_nop 0
    buffer_load_dwordx4 v233, s[20:23], s66 offen lds
    s_add_u32 m0, s69, 1024
    v_mfma_f32_32x32x16_bf16 v[112:127], a[116:119], v[164:167], v[112:127]
    buffer_load_dwordx4 v233, s[24:27], s66 offen lds
    s_add_u32 s66, s66, 57344
    s_cmp_lt_u32 s66, 1835008
    s_cselect_b32 s66, s66, 917504
    v_mfma_f32_32x32x16_bf16 v[32:47], a[120:123], v[168:171], v[32:47]
    ds_read_b128 v[188:191], v236 offset:16384
    v_mfma_f32_32x32x16_bf16 v[48:63], a[124:127], v[168:171], v[48:63]
    v_mfma_f32_32x32x16_bf16 v[64:79], a[120:123], v[172:175], v[64:79]
    ds_read_b128 v[160:163], v227 offset:17408
    s_waitcnt lgkmcnt(4)
    s_add_u32 m0, s69, 2048
    s_nop 0
    buffer_load_dwordx4 v233, s[20:23], s66 offen lds
    s_add_u32 m0, s69, 3072
    v_mfma_f32_32x32x16_bf16 v[80:95], a[124:127], v[172:175], v[80:95]
    buffer_load_dwordx4 v233, s[24:27], s66 offen lds
    s_add_u32 s66, s66, 57344
    s_cmp_lt_u32 s66, 1835008
    s_cselect_b32 s66, s66, 917504
    s_waitcnt lgkmcnt(3)
    v_mfma_f32_32x32x16_bf16 v[96:111], a[120:123], v[176:179], v[96:111]
    ds_read_b128 v[164:167], v227 offset:18432
    v_mfma_f32_32x32x16_bf16 v[112:127], a[124:127], v[176:179], v[112:127]
    s_waitcnt vmcnt(14)
    ds_read_b64_tr_b16 a[192:193], v10 offset:4096
    ds_read_b64_tr_b16 a[194:195], v10 offset:4352
    ds_read_b64_tr_b16 a[196:197], v10 offset:5120
    ds_read_b64_tr_b16 a[198:199], v10 offset:5376
    v_mfma_f32_32x32x16_bf16 v[32:47], a[128:131], v[180:183], v[32:47]
    ds_read_b128 v[168:171], v227 offset:19456
    v_mfma_f32_32x32x16_bf16 v[48:63], a[132:135], v[180:183], v[48:63]
    s_waitcnt vmcnt(12)
    ds_read_b64_tr_b16 a[200:201], v14 offset:4096
    ds_read_b64_tr_b16 a[202:203], v14 offset:4352
    ds_read_b64_tr_b16 a[204:205], v14 offset:5120
    ds_read_b64_tr_b16 a[206:207], v14 offset:5376
    s_waitcnt lgkmcnt(11)
    v_mfma_f32_32x32x16_bf16 v[64:79], a[128:131], v[184:187], v[64:79]
    ds_read_b128 v[172:175], v227 offset:20480
    v_mfma_f32_32x32x16_bf16 v[80:95], a[132:135], v[184:187], v[80:95]
    v_mfma_f32_32x32x16_bf16 v[96:111], a[128:131], v[188:191], v[96:111]
    ds_read_b128 v[176:179], v227 offset:21504
    v_mfma_f32_32x32x16_bf16 v[112:127], a[132:135], v[188:191], v[112:127]
    s_waitcnt lgkmcnt(11)
    v_mfma_f32_32x32x16_bf16 v[32:47], a[136:139], v[160:163], v[32:47]
    ds_read_b128 v[180:183], v227 offset:22528
    s_add_u32 m0, s68, 8192
    s_add_u32 s54, s67, 0
    buffer_load_dwordx4 v226, s[28:31], s54 offen lds
    v_mfma_f32_32x32x16_bf16 v[48:63], a[140:143], v[160:163], v[48:63]
    s_waitcnt vmcnt(11)
    ds_read_b64_tr_b16 a[208:209], v14 offset:6144
    ds_read_b64_tr_b16 a[210:211], v14 offset:6400
    ds_read_b64_tr_b16 a[212:213], v14 offset:7168
    ds_read_b64_tr_b16 a[214:215], v14 offset:7424
    buffer_load_dwordx4 v12, s[28:31], s54 offen offset:1024 lds
    v_mfma_f32_32x32x16_bf16 v[32:47], a[144:147], v[164:167], v[32:47]
    ds_read_b128 v[184:187], v227 offset:23552
    v_mfma_f32_32x32x16_bf16 v[48:63], a[148:151], v[164:167], v[48:63]
    s_barrier
    s_waitcnt lgkmcnt(7)
    v_mfma_f32_32x32x16_bf16 v[32:47], a[152:155], v[168:171], v[32:47]
    ds_read_b128 v[188:191], v227 offset:24576
    v_mfma_f32_32x32x16_bf16 v[48:63], a[156:159], v[168:171], v[48:63]
    s_waitcnt vmcnt(10)
    ds_read_b64_tr_b16 a[216:217], v10 offset:6144
    ds_read_b64_tr_b16 a[218:219], v10 offset:6400
    ds_read_b64_tr_b16 a[220:221], v10 offset:7168
    ds_read_b64_tr_b16 a[222:223], v10 offset:7424
    v_mfma_f32_32x32x16_bf16 v[32:47], a[160:163], v[172:175], v[32:47]
    ds_read_b128 v[160:163], v227 offset:25600
    s_add_u32 m0, s68, 10240
    s_add_u32 s54, s67, 16384
    buffer_load_dwordx4 v226, s[28:31], s54 offen lds
    v_mfma_f32_32x32x16_bf16 v[48:63], a[164:167], v[172:175], v[48:63]
    buffer_load_dwordx4 v12, s[28:31], s54 offen offset:1024 lds
    s_waitcnt lgkmcnt(11)
    v_mfma_f32_32x32x16_bf16 v[32:47], a[168:171], v[176:179], v[32:47]
    ds_read_b128 v[164:167], v227 offset:26624
    v_mfma_f32_32x32x16_bf16 v[48:63], a[172:175], v[176:179], v[48:63]
    s_waitcnt vmcnt(10)
    ds_read_b64_tr_b16 a[224:225], v14 offset:0
    ds_read_b64_tr_b16 a[226:227], v14 offset:256
    ds_read_b64_tr_b16 a[228:229], v14 offset:1024
    ds_read_b64_tr_b16 a[230:231], v14 offset:1280
    v_mfma_f32_32x32x16_bf16 v[32:47], a[176:179], v[180:183], v[32:47]
    ds_read_b128 v[168:171], v227 offset:27648
    v_mfma_f32_32x32x16_bf16 v[48:63], a[180:183], v[180:183], v[48:63]
    s_waitcnt lgkmcnt(11)
    v_mfma_f32_32x32x16_bf16 v[32:47], a[184:187], v[184:187], v[32:47]
    ds_read_b128 v[172:175], v227 offset:28672
    s_add_u32 m0, s69, 4096
    s_add_u32 s54, s67, 32768
    buffer_load_dwordx4 v226, s[28:31], s54 offen lds
    v_mfma_f32_32x32x16_bf16 v[48:63], a[188:191], v[184:187], v[48:63]
    s_waitcnt vmcnt(9)
    ds_read_b64_tr_b16 a[232:233], v14 offset:2048
    ds_read_b64_tr_b16 a[234:235], v14 offset:2304
    ds_read_b64_tr_b16 a[236:237], v14 offset:3072
    ds_read_b64_tr_b16 a[238:239], v14 offset:3328
    buffer_load_dwordx4 v12, s[28:31], s54 offen offset:1024 lds
    v_mfma_f32_32x32x16_bf16 v[32:47], a[192:195], v[188:191], v[32:47]
    ds_read_b128 v[176:179], v227 offset:29696
    v_mfma_f32_32x32x16_bf16 v[48:63], a[196:199], v[188:191], v[48:63]
    s_waitcnt lgkmcnt(11)
    v_mfma_f32_32x32x16_bf16 v[32:47], a[200:203], v[160:163], v[32:47]
    ds_read_b128 v[180:183], v227 offset:30720
    v_mfma_f32_32x32x16_bf16 v[48:63], a[204:207], v[160:163], v[48:63]
    v_mfma_f32_32x32x16_bf16 v[32:47], a[208:211], v[164:167], v[32:47]
    ds_read_b128 v[184:187], v227 offset:31744
    s_add_u32 m0, s68, 4096
    s_add_u32 s54, s67, 49152
    buffer_load_dwordx4 v226, s[28:31], s54 offen lds
    v_mfma_f32_32x32x16_bf16 v[48:63], a[212:215], v[164:167], v[48:63]
    s_waitcnt vmcnt(9)
    ds_read_b64_tr_b16 a[240:241], v10 offset:0
    ds_read_b64_tr_b16 a[242:243], v10 offset:256
    ds_read_b64_tr_b16 a[244:245], v10 offset:1024
    ds_read_b64_tr_b16 a[246:247], v10 offset:1280
    buffer_load_dwordx4 v12, s[28:31], s54 offen offset:1024 lds
    s_waitcnt lgkmcnt(11)
    v_mfma_f32_32x32x16_bf16 v[32:47], a[216:219], v[168:171], v[32:47]
    ds_read_b128 v[188:191], v227 offset:50176
    v_mfma_f32_32x32x16_bf16 v[48:63], a[220:223], v[168:171], v[48:63]
    v_mfma_f32_32x32x16_bf16 v[32:47], a[224:227], v[172:175], v[32:47]
    ds_read_b128 v[160:163], v227 offset:51200
    v_mfma_f32_32x32x16_bf16 v[48:63], a[228:231], v[172:175], v[48:63]
    s_waitcnt vmcnt(8)
    ds_read_b64_tr_b16 a[248:249], v10 offset:2048
    ds_read_b64_tr_b16 a[250:251], v10 offset:2304
    ds_read_b64_tr_b16 a[252:253], v10 offset:3072
    ds_read_b64_tr_b16 a[254:255], v10 offset:3328
    s_waitcnt lgkmcnt(11)
    v_mfma_f32_32x32x16_bf16 v[32:47], a[232:235], v[176:179], v[32:47]
    ds_read_b128 v[164:167], v227 offset:52224
    s_add_u32 m0, s68, 6144
    s_add_u32 s54, s67, 65536
    buffer_load_dwordx4 v226, s[28:31], s54 offen lds
    v_mfma_f32_32x32x16_bf16 v[48:63], a[236:239], v[176:179], v[48:63]
    buffer_load_dwordx4 v12, s[28:31], s54 offen offset:1024 lds
    s_waitcnt lgkmcnt(7)
    v_mfma_f32_32x32x16_bf16 v[32:47], a[240:243], v[180:183], v[32:47]
    ds_read_b128 v[168:171], v227 offset:53248
    v_mfma_f32_32x32x16_bf16 v[48:63], a[244:247], v[180:183], v[48:63]
    s_waitcnt lgkmcnt(2)
    v_mfma_f32_32x32x16_bf16 v[32:47], a[248:251], v[184:187], v[32:47]
    ds_read_b128 v[172:175], v227 offset:54272
    v_mfma_f32_32x32x16_bf16 v[48:63], a[252:255], v[184:187], v[48:63]
    v_mfma_f32_32x32x16_bf16 v[64:79], a[136:139], v[188:191], v[64:79]
    ds_read_b128 v[176:179], v227 offset:55296
    s_add_u32 m0, s40, 12288
    s_add_u32 s54, s67, 81920
    buffer_load_dwordx4 v226, s[28:31], s54 offen lds
    v_mfma_f32_32x32x16_bf16 v[80:95], a[140:143], v[188:191], v[80:95]
    buffer_load_dwordx4 v12, s[28:31], s54 offen offset:1024 lds
    s_waitcnt lgkmcnt(3)
    v_mfma_f32_32x32x16_bf16 v[64:79], a[144:147], v[160:163], v[64:79]
    ds_read_b128 v[180:183], v227 offset:56320
    v_mfma_f32_32x32x16_bf16 v[80:95], a[148:151], v[160:163], v[80:95]
    v_mfma_f32_32x32x16_bf16 v[64:79], a[152:155], v[164:167], v[64:79]
    ds_read_b128 v[184:187], v227 offset:57344
    v_exp_f32 v192, -v32
    v_mul_f32 v32, v32, v48
    v_exp_f32 v193, -v33
    v_mul_f32 v33, v33, v49
    v_mfma_f32_32x32x16_bf16 v[80:95], a[156:159], v[164:167], v[80:95]
    v_fma_f32 v192, v192, s70, s70
    v_exp_f32 v194, -v34
    v_mul_f32 v34, v34, v50
    v_fma_f32 v193, v193, s70, s70
    s_waitcnt lgkmcnt(3)
    v_mfma_f32_32x32x16_bf16 v[64:79], a[160:163], v[168:171], v[64:79]
    ds_read_b128 v[188:191], v227 offset:58368
    s_add_u32 m0, s69, 6144
    s_add_u32 s54, s67, 98304
    buffer_load_dwordx4 v226, s[28:31], s54 offen lds
    v_rcp_f32 v192, v192
    v_mfma_f32_32x32x16_bf16 v[80:95], a[164:167], v[168:171], v[80:95]
    s_waitcnt vmcnt(11)
    ds_read_b64_tr_b16 a[0:1], v6 offset:8192
    ds_read_b64_tr_b16 a[2:3], v6 offset:8704
    ds_read_b64_tr_b16 a[4:5], v7 offset:8192
    ds_read_b64_tr_b16 a[6:7], v7 offset:8704
    buffer_load_dwordx4 v12, s[28:31], s54 offen offset:1024 lds
    v_mfma_f32_32x32x16_bf16 v[64:79], a[168:171], v[172:175], v[64:79]
    ds_read_b128 v[160:163], v227 offset:59392
    v_exp_f32 v195, -v35
    v_mul_f32 v35, v35, v51
    v_fma_f32 v194, v194, s70, s70
    v_rcp_f32 v193, v193
    v_mfma_f32_32x32x16_bf16 v[80:95], a[172:175], v[172:175], v[80:95]
    v_mul_f32 v32, v32, v192
    v_exp_f32 v196, -v36
    v_mul_f32 v36, v36, v52
    v_fma_f32 v195, v195, s70, s70
    s_waitcnt lgkmcnt(7)
    v_mfma_f32_32x32x16_bf16 v[64:79], a[176:179], v[176:179], v[64:79]
    ds_read_b128 v[164:167], v227 offset:60416
    v_rcp_f32 v194, v194
    v_mul_f32 v33, v33, v193
    v_exp_f32 v197, -v37
    v_mul_f32 v37, v37, v53
    v_mfma_f32_32x32x16_bf16 v[80:95], a[180:183], v[176:179], v[80:95]
    v_fma_f32 v196, v196, s70, s70
    v_rcp_f32 v195, v195
    v_mul_f32 v34, v34, v194
    v_cvt_pk_bf16_f32 v208, v32, v33
    v_exp_f32 v198, -v38
    v_mfma_f32_32x32x16_bf16 v[64:79], a[184:187], v[180:183], v[64:79]
    ds_read_b128 v[168:171], v227 offset:61440
    s_add_u32 m0, s68, 0
    s_add_u32 s54, s67, 114688
    buffer_load_dwordx4 v226, s[28:31], s54 offen lds
    v_mul_f32 v38, v38, v54
    v_fma_f32 v197, v197, s70, s70
    v_mfma_f32_32x32x16_bf16 v[80:95], a[188:191], v[180:183], v[80:95]
    s_waitcnt vmcnt(11)
    ds_read_b64_tr_b16 a[8:9], v6 offset:10240
    ds_read_b64_tr_b16 a[10:11], v6 offset:10752
    ds_read_b64_tr_b16 a[12:13], v7 offset:10240
    ds_read_b64_tr_b16 a[14:15], v7 offset:10752
    buffer_load_dwordx4 v12, s[28:31], s54 offen offset:1024 lds
    s_waitcnt lgkmcnt(11)
    v_mfma_f32_32x32x16_bf16 v[64:79], a[192:195], v[184:187], v[64:79]
    ds_read_b128 v[172:175], v227 offset:62464
    v_rcp_f32 v196, v196
    v_mul_f32 v35, v35, v195
    v_exp_f32 v199, -v39
    v_mul_f32 v39, v39, v55
    v_mfma_f32_32x32x16_bf16 v[80:95], a[196:199], v[184:187], v[80:95]
    v_fma_f32 v198, v198, s70, s70
    v_rcp_f32 v197, v197
    v_mul_f32 v36, v36, v196
    v_cvt_pk_bf16_f32 v209, v34, v35
    v_exp_f32 v200, -v40
    v_mfma_f32_32x32x16_bf16 v[64:79], a[200:203], v[188:191], v[64:79]
    ds_read_b128 v[176:179], v227 offset:63488
    v_mul_f32 v40, v40, v56
    v_fma_f32 v199, v199, s70, s70
    v_rcp_f32 v198, v198
    v_mul_f32 v37, v37, v197
    v_mfma_f32_32x32x16_bf16 v[80:95], a[204:207], v[188:191], v[80:95]
    v_exp_f32 v201, -v41
    v_mul_f32 v41, v41, v57
    v_fma_f32 v200, v200, s70, s70
    v_rcp_f32 v199, v199
    s_waitcnt lgkmcnt(7)
    v_mfma_f32_32x32x16_bf16 v[64:79], a[208:211], v[160:163], v[64:79]
    ds_read_b128 v[180:183], v227 offset:64512
    s_add_u32 m0, s68, 2048
    s_add_u32 s54, s67, 131072
    buffer_load_dwordx4 v226, s[28:31], s54 offen lds
    v_mul_f32 v38, v38, v198
    v_cvt_pk_bf16_f32 v210, v36, v37
    v_mfma_f32_32x32x16_bf16 v[80:95], a[212:215], v[160:163], v[80:95]
    s_waitcnt vmcnt(11)
    ds_read_b64_tr_b16 a[16:17], v8 offset:4096
    ds_read_b64_tr_b16 a[18:19], v8 offset:4608
    ds_read_b64_tr_b16 a[20:21], v9 offset:4096
    ds_read_b64_tr_b16 a[22:23], v9 offset:4608
    buffer_load_dwordx4 v12, s[28:31], s54 offen offset:1024 lds
    v_mfma_f32_32x32x16_bf16 v[64:79], a[216:219], v[164:167], v[64:79]
    ds_read_b128 v[184:187], v236 offset:17408
    v_exp_f32 v202, -v42
    v_mul_f32 v42, v42, v58
    v_fma_f32 v201, v201, s70, s70
    v_rcp_f32 v200, v200
    v_mfma_f32_32x32x16_bf16 v[80:95], a[220:223], v[164:167], v[80:95]
    v_mul_f32 v39, v39, v199
    v_exp_f32 v203, -v43
    v_mul_f32 v43, v43, v59
    v_fma_f32 v202, v202, s70, s70
    s_waitcnt lgkmcnt(7)
    v_mfma_f32_32x32x16_bf16 v[64:79], a[224:227], v[168:171], v[64:79]
    ds_read_b128 v[188:191], v236 offset:18432
    v_rcp_f32 v201, v201
    v_mul_f32 v40, v40, v200
    v_cvt_pk_bf16_f32 v211, v38, v39
    v_exp_f32 v204, -v44
    v_mfma_f32_32x32x16_bf16 v[80:95], a[228:231], v[168:171], v[80:95]
    v_mul_f32 v44, v44, v60
    v_fma_f32 v203, v203, s70, s70
    v_rcp_f32 v202, v202
    v_mul_f32 v41, v41, v201
    v_exp_f32 v205, -v45
    v_mfma_f32_32x32x16_bf16 v[64:79], a[232:235], v[172:175], v[64:79]
    ds_read_b128 v[160:163], v236 offset:19456
    s_add_u32 m0, s69, 0
    s_add_u32 s54, s67, 147456
    buffer_load_dwordx4 v226, s[28:31], s54 offen lds
    v_mul_f32 v45, v45, v61
    v_fma_f32 v204, v204, s70, s70
    v_mfma_f32_32x32x16_bf16 v[80:95], a[236:239], v[172:175], v[80:95]
    s_waitcnt vmcnt(11)
    ds_read_b64_tr_b16 a[24:25], v6 offset:4096
    ds_read_b64_tr_b16 a[26:27], v6 offset:4608
    ds_read_b64_tr_b16 a[28:29], v7 offset:4096
    ds_read_b64_tr_b16 a[30:31], v7 offset:4608
    buffer_load_dwordx4 v12, s[28:31], s54 offen offset:1024 lds
    s_waitcnt lgkmcnt(11)
    v_mfma_f32_32x32x16_bf16 v[64:79], a[240:243], v[176:179], v[64:79]
    ds_read_b128 v[164:167], v236 offset:20480
    v_rcp_f32 v203, v203
    v_mul_f32 v42, v42, v202
    v_cvt_pk_bf16_f32 v212, v40, v41
    v_exp_f32 v206, -v46
    v_mfma_f32_32x32x16_bf16 v[80:95], a[244:247], v[176:179], v[80:95]
    v_mul_f32 v46, v46, v62
    v_fma_f32 v205, v205, s70, s70
    v_rcp_f32 v204, v204
    v_mul_f32 v43, v43, v203
    v_exp_f32 v207, -v47
    v_mfma_f32_32x32x16_bf16 v[64:79], a[248:251], v[180:183], v[64:79]
    ds_read_b128 v[168:171], v236 offset:21504
    v_mul_f32 v47, v47, v63
    v_fma_f32 v206, v206, s70, s70
    v_rcp_f32 v205, v205
    v_mul_f32 v44, v44, v204
    v_cvt_pk_bf16_f32 v213, v42, v43
    v_mfma_f32_32x32x16_bf16 v[80:95], a[252:255], v[180:183], v[80:95]
    v_fma_f32 v207, v207, s70, s70
    v_rcp_f32 v206, v206
    v_mul_f32 v45, v45, v205
    v_rcp_f32 v207, v207
    s_waitcnt lgkmcnt(7)
    v_mfma_f32_32x32x16_bf16 v[96:111], a[136:139], v[184:187], v[96:111]
    ds_read_b128 v[172:175], v236 offset:22528
    s_add_u32 m0, s69, 2048
    s_add_u32 s54, s67, 163840
    buffer_load_dwordx4 v226, s[28:31], s54 offen lds
    v_mul_f32 v46, v46, v206
    v_cvt_pk_bf16_f32 v214, v44, v45
    v_mfma_f32_32x32x16_bf16 v[112:127], a[140:143], v[184:187], v[112:127]
    buffer_load_dwordx4 v12, s[28:31], s54 offen offset:1024 lds
    v_mul_f32 v47, v47, v207
    v_cvt_pk_bf16_f32 v215, v46, v47
    v_mfma_f32_32x32x16_bf16 v[96:111], a[144:147], v[188:191], v[96:111]
    ds_read_b128 v[176:179], v236 offset:23552
    s_add_u32 s49, s60, 0
    buffer_store_dwordx4 v[208:211], v227, s[36:39], s49 offen sc1
    buffer_store_dwordx4 v[212:215], v227, s[36:39], s49 offen offset:1024 sc1
    v_mfma_f32_32x32x16_bf16 v[112:127], a[148:151], v[188:191], v[112:127]
    s_waitcnt lgkmcnt(3)
    v_mfma_f32_32x32x16_bf16 v[96:111], a[152:155], v[160:163], v[96:111]
    ds_read_b128 v[180:183], v236 offset:24576
    v_mfma_f32_32x32x16_bf16 v[112:127], a[156:159], v[160:163], v[112:127]
    v_exp_f32 v192, -v64
    v_mul_f32 v64, v64, v80
    v_exp_f32 v193, -v65
    v_mul_f32 v65, v65, v81
    v_mfma_f32_32x32x16_bf16 v[96:111], a[160:163], v[164:167], v[96:111]
    ds_read_b128 v[184:187], v236 offset:25600
    s_add_u32 m0, s68, 8192
    s_add_u32 s54, s67, 180224
    buffer_load_dwordx4 v226, s[28:31], s54 offen lds
    v_fma_f32 v192, v192, s70, s70
    v_mfma_f32_32x32x16_bf16 v[112:127], a[164:167], v[164:167], v[112:127]
    buffer_load_dwordx4 v12, s[28:31], s54 offen offset:1024 lds
    v_exp_f32 v194, -v66
    v_mul_f32 v66, v66, v82
    v_fma_f32 v193, v193, s70, s70
    s_waitcnt lgkmcnt(3)
    v_mfma_f32_32x32x16_bf16 v[96:111], a[168:171], v[168:171], v[96:111]
    ds_read_b128 v[188:191], v236 offset:26624
    v_rcp_f32 v192, v192
    v_exp_f32 v195, -v67
    v_mul_f32 v67, v67, v83
    v_mfma_f32_32x32x16_bf16 v[112:127], a[172:175], v[168:171], v[112:127]
    v_fma_f32 v194, v194, s70, s70
    v_rcp_f32 v193, v193
    v_mul_f32 v64, v64, v192
    v_exp_f32 v196, -v68
    v_mfma_f32_32x32x16_bf16 v[96:111], a[176:179], v[172:175], v[96:111]
    ds_read_b128 v[160:163], v236 offset:27648
    v_mul_f32 v68, v68, v84
    v_fma_f32 v195, v195, s70, s70
    v_rcp_f32 v194, v194
    v_mul_f32 v65, v65, v193
    v_mfma_f32_32x32x16_bf16 v[112:127], a[180:183], v[172:175], v[112:127]
    v_exp_f32 v197, -v69
    v_mul_f32 v69, v69, v85
    v_fma_f32 v196, v196, s70, s70
    s_waitcnt lgkmcnt(3)
    v_mfma_f32_32x32x16_bf16 v[96:111], a[184:187], v[176:179], v[96:111]
    ds_read_b128 v[164:167], v236 offset:28672
    s_add_u32 m0, s68, 10240
    s_add_u32 s54, s67, 196608
    buffer_load_dwordx4 v226, s[28:31], s54 offen lds
    v_mfma_f32_32x32x16_bf16 v[112:127], a[188:191], v[176:179], v[112:127]
    buffer_load_dwordx4 v12, s[28:31], s54 offen offset:1024 lds
    v_rcp_f32 v195, v195
    v_mul_f32 v66, v66, v194
    v_cvt_pk_bf16_f32 v208, v64, v65
    v_mfma_f32_32x32x16_bf16 v[96:111], a[192:195], v[180:183], v[96:111]
    ds_read_b128 v[168:171], v236 offset:29696
    v_exp_f32 v198, -v70
    v_mul_f32 v70, v70, v86
    v_fma_f32 v197, v197, s70, s70
    v_mfma_f32_32x32x16_bf16 v[112:127], a[196:199], v[180:183], v[112:127]
    v_rcp_f32 v196, v196
    v_mul_f32 v67, v67, v195
    v_exp_f32 v199, -v71
    s_waitcnt lgkmcnt(3)
    v_mfma_f32_32x32x16_bf16 v[96:111], a[200:203], v[184:187], v[96:111]
    ds_read_b128 v[172:175], v236 offset:30720
    v_mul_f32 v71, v71, v87
    v_fma_f32 v198, v198, s70, s70
    v_rcp_f32 v197, v197
    v_mul_f32 v68, v68, v196
    v_mfma_f32_32x32x16_bf16 v[112:127], a[204:207], v[184:187], v[112:127]
    v_cvt_pk_bf16_f32 v209, v66, v67
    v_exp_f32 v200, -v72
    v_mul_f32 v72, v72, v88
    v_fma_f32 v199, v199, s70, s70
    v_mfma_f32_32x32x16_bf16 v[96:111], a[208:211], v[188:191], v[96:111]
    ds_read_b128 v[176:179], v236 offset:31744
    s_add_u32 m0, s69, 4096
    s_add_u32 s54, s67, 212992
    buffer_load_dwordx4 v226, s[28:31], s54 offen lds
    v_mfma_f32_32x32x16_bf16 v[112:127], a[212:215], v[188:191], v[112:127]
    buffer_load_dwordx4 v12, s[28:31], s54 offen offset:1024 lds
    v_rcp_f32 v198, v198
    v_mul_f32 v69, v69, v197
    s_waitcnt lgkmcnt(3)
    v_mfma_f32_32x32x16_bf16 v[96:111], a[216:219], v[160:163], v[96:111]
    ds_read_b128 v[180:183], v236 offset:46080
    v_exp_f32 v201, -v73
    v_mul_f32 v73, v73, v89
    v_fma_f32 v200, v200, s70, s70
    v_mfma_f32_32x32x16_bf16 v[112:127], a[220:223], v[160:163], v[112:127]
    v_rcp_f32 v199, v199
    v_mul_f32 v70, v70, v198
    v_cvt_pk_bf16_f32 v210, v68, v69
    v_exp_f32 v202, -v74
    v_mfma_f32_32x32x16_bf16 v[96:111], a[224:227], v[164:167], v[96:111]
    ds_read_b128 v[184:187], v236 offset:47104
    v_mul_f32 v74, v74, v90
    v_fma_f32 v201, v201, s70, s70
    v_rcp_f32 v200, v200
    v_mul_f32 v71, v71, v199
    v_mov_b32 v16, 8192
    v_mov_b32 v17, s3
    s_waitcnt vmcnt(6)
    s_mov_b64 exec, 1
    s_cmp_eq_u32 s44, 0
    s_cbranch_scc1 L_slow_15
    buffer_store_dword v17, v16, s[36:39], s5 offen
L_slow_15_j:
    s_mov_b64 exec, -1
    v_mfma_f32_32x32x16_bf16 v[112:127], a[228:231], v[164:167], v[112:127]
    v_exp_f32 v203, -v75
    v_mul_f32 v75, v75, v91
    v_fma_f32 v202, v202, s70, s70
    s_waitcnt lgkmcnt(3)
    v_mfma_f32_32x32x16_bf16 v[96:111], a[232:235], v[168:171], v[96:111]
    ds_read_b128 v[188:191], v236 offset:48128
    v_rcp_f32 v201, v201
    v_mul_f32 v72, v72, v200
    v_cvt_pk_bf16_f32 v211, v70, v71
    v_mfma_f32_32x32x16_bf16 v[112:127], a[236:239], v[168:171], v[112:127]
    v_exp_f32 v204, -v76
    v_mul_f32 v76, v76, v92
    v_fma_f32 v203, v203, s70, s70
    v_rcp_f32 v202, v202
    v_mfma_f32_32x32x16_bf16 v[96:111], a[240:243], v[172:175], v[96:111]
    ds_read_b128 v[160:163], v236 offset:49152
    v_mul_f32 v73, v73, v201
    v_exp_f32 v205, -v77
    v_mul_f32 v77, v77, v93
    v_fma_f32 v204, v204, s70, s70
    v_mfma_f32_32x32x16_bf16 v[112:127], a[244:247], v[172:175], v[112:127]
    v_rcp_f32 v203, v203
    v_mul_f32 v74, v74, v202
    v_cvt_pk_bf16_f32 v212, v72, v73
    s_waitcnt lgkmcnt(3)
    v_mfma_f32_32x32x16_bf16 v[96:111], a[248:251], v[176:179], v[96:111]
    ds_read_b128 v[164:167], v236 offset:50176
    v_exp_f32 v206, -v78
    v_mul_f32 v78, v78, v94
    v_fma_f32 v205, v205, s70, s70
    v_mfma_f32_32x32x16_bf16 v[112:127], a[252:255], v[176:179], v[112:127]
    v_rcp_f32 v204, v204
    v_mul_f32 v75, v75, v203
    v_exp_f32 v207, -v79
    v_mul_f32 v79, v79, v95
    v_mfma_f32_32x32x16_bf16 v[128:143], a[104:107], v[180:183], v[128:143]
    ds_read_b128 v[168:171], v236 offset:51200
    v_fma_f32 v206, v206, s70, s70
    v_rcp_f32 v205, v205
    v_mul_f32 v76, v76, v204
    v_cvt_pk_bf16_f32 v213, v74, v75
    v_mfma_f32_32x32x16_bf16 v[144:159], a[108:111], v[180:183], v[144:159]
    v_fma_f32 v207, v207, s70, s70
    v_rcp_f32 v206, v206
    v_mul_f32 v77, v77, v205
    s_waitcnt lgkmcnt(3)
    v_mfma_f32_32x32x16_bf16 v[128:143], a[112:115], v[184:187], v[128:143]
    ds_read_b128 v[172:175], v236 offset:52224
    v_rcp_f32 v207, v207
    v_mul_f32 v78, v78, v206
    v_cvt_pk_bf16_f32 v214, v76, v77
    v_mul_f32 v79, v79, v207
    v_mfma_f32_32x32x16_bf16 v[144:159], a[116:119], v[184:187], v[144:159]
    v_cvt_pk_bf16_f32 v215, v78, v79
    s_add_u32 s51, s71, 8192
    buffer_load_dword v18, v239, s[36:39], s51 offen sc1
    v_mfma_f32_32x32x16_bf16 v[128:143], a[120:123], v[188:191], v[128:143]
    ds_read_b128 v[176:179], v236 offset:53248
    s_add_u32 s49, s60, 114688
    buffer_store_dwordx4 v[208:211], v227, s[36:39], s49 offen sc1
    buffer_store_dwordx4 v[212:215], v227, s[36:39], s49 offen offset:1024 sc1
    v_mfma_f32_32x32x16_bf16 v[144:159], a[124:127], v[188:191], v[144:159]
    s_waitcnt lgkmcnt(3)
    v_mfma_f32_32x32x16_bf16 v[128:143], a[128:131], v[160:163], v[128:143]
    ds_read_b128 v[180:183], v236 offset:54272
    v_exp_f32 v192, -v96
    v_mul_f32 v96, v96, v112
    v_exp_f32 v193, -v97
    v_mfma_f32_32x32x16_bf16 v[144:159], a[132:135], v[160:163], v[144:159]
    v_mul_f32 v97, v97, v113
    v_fma_f32 v192, v192, s70, s70
    v_exp_f32 v194, -v98
    v_mul_f32 v98, v98, v114
    v_fma_f32 v193, v193, s70, s70
    v_mfma_f32_32x32x16_bf16 v[128:143], a[136:139], v[164:167], v[128:143]
    ds_read_b128 v[184:187], v236 offset:55296
    v_rcp_f32 v192, v192
    v_exp_f32 v195, -v99
    v_mul_f32 v99, v99, v115
    v_mfma_f32_32x32x16_bf16 v[144:159], a[140:143], v[164:167], v[144:159]
    v_fma_f32 v194, v194, s70, s70
    v_rcp_f32 v193, v193
    v_mul_f32 v96, v96, v192
    s_waitcnt lgkmcnt(3)
    v_mfma_f32_32x32x16_bf16 v[128:143], a[144:147], v[168:171], v[128:143]
    ds_read_b128 v[188:191], v236 offset:56320
    v_exp_f32 v196, -v100
    v_mul_f32 v100, v100, v116
    v_fma_f32 v195, v195, s70, s70
    v_mfma_f32_32x32x16_bf16 v[144:159], a[148:151], v[168:171], v[144:159]
    v_rcp_f32 v194, v194
    v_mul_f32 v97, v97, v193
    v_exp_f32 v197, -v101
    v_mul_f32 v101, v101, v117
    v_mfma_f32_32x32x16_bf16 v[128:143], a[152:155], v[172:175], v[128:143]
    ds_read_b128 v[160:163], v236 offset:57344
    v_fma_f32 v196, v196, s70, s70
    v_rcp_f32 v195, v195
    v_mul_f32 v98, v98, v194
    v_cvt_pk_bf16_f32 v208, v96, v97
    v_mfma_f32_32x32x16_bf16 v[144:159], a[156:159], v[172:175], v[144:159]
    v_exp_f32 v198, -v102
    v_mul_f32 v102, v102, v118
    v_fma_f32 v197, v197, s70, s70
    s_waitcnt lgkmcnt(3)
    v_mfma_f32_32x32x16_bf16 v[128:143], a[160:163], v[176:179], v[128:143]
    ds_read_b128 v[164:167], v236 offset:58368
    v_rcp_f32 v196, v196
    v_mul_f32 v99, v99, v195
    v_exp_f32 v199, -v103
    v_mfma_f32_32x32x16_bf16 v[144:159], a[164:167], v[176:179], v[144:159]
    v_mul_f32 v103, v103, v119
    v_fma_f32 v198, v198, s70, s70
    v_rcp_f32 v197, v197
    v_mul_f32 v100, v100, v196
    v_cvt_pk_bf16_f32 v209, v98, v99
    s_waitcnt vmcnt(2)
    v_cmp_ne_u32 vcc, s3, v18
    s_mov_b32 s55, 0
    s_and_b64 vcc, vcc, s[14:15]
    s_cbranch_vccnz L_poll_16
L_poll_16_ok:
    v_mfma_f32_32x32x16_bf16 v[128:143], a[168:171], v[180:183], v[128:143]
    ds_read_b128 v[168:171], v236 offset:59392
    v_exp_f32 v200, -v104
    v_mul_f32 v104, v104, v120
    v_fma_f32 v199, v199, s70, s70
    v_mfma_f32_32x32x16_bf16 v[144:159], a[172:175], v[180:183], v[144:159]
    v_rcp_f32 v198, v198
    v_mul_f32 v101, v101, v197
    s_add_u32 s53, s8, 0
    buffer_load_dwordx4 v[32:35], v227, s[36:39], s53 offen offset:0 sc1
    s_waitcnt lgkmcnt(3)
    v_mfma_f32_32x32x16_bf16 v[128:143], a[176:179], v[184:187], v[128:143]
    ds_read_b128 v[172:175], v236 offset:60416
    v_exp_f32 v201, -v105
    v_mul_f32 v105, v105, v121
    v_fma_f32 v200, v200, s70, s70
    v_mfma_f32_32x32x16_bf16 v[144:159], a[180:183], v[184:187], v[144:159]
    v_rcp_f32 v199, v199
    v_mul_f32 v102, v102, v198
    v_cvt_pk_bf16_f32 v210, v100, v101
    buffer_load_dwordx4 v[36:39], v227, s[36:39], s53 offen offset:1024 sc1
    v_mfma_f32_32x32x16_bf16 v[128:143], a[184:187], v[188:191], v[128:143]
    ds_read_b128 v[176:179], v236 offset:61440
    v_exp_f32 v202, -v106
    v_mul_f32 v106, v106, v122
    v_fma_f32 v201, v201, s70, s70
    v_mfma_f32_32x32x16_bf16 v[144:159], a[188:191], v[188:191], v[144:159]
    v_rcp_f32 v200, v200
    v_mul_f32 v103, v103, v199
    buffer_load_dwordx4 v[40:43], v227, s[36:39], s53 offen offset:2048 sc1
    s_waitcnt lgkmcnt(3)
    v_mfma_f32_32x32x16_bf16 v[128:143], a[192:195], v[160:163], v[128:143]
    ds_read_b128 v[180:183], v236 offset:62464
    v_exp_f32 v203, -v107
    v_mul_f32 v107, v107, v123
    v_fma_f32 v202, v202, s70, s70
    v_mfma_f32_32x32x16_bf16 v[144:159], a[196:199], v[160:163], v[144:159]
    v_rcp_f32 v201, v201
    v_mul_f32 v104, v104, v200
    v_cvt_pk_bf16_f32 v211, v102, v103
    buffer_load_dwordx4 v[44:47], v227, s[36:39], s53 offen offset:3072 sc1
    v_mfma_f32_32x32x16_bf16 v[128:143], a[200:203], v[164:167], v[128:143]
    ds_read_b128 v[184:187], v236 offset:63488
    v_exp_f32 v204, -v108
    v_mul_f32 v108, v108, v124
    v_fma_f32 v203, v203, s70, s70
    v_mov_b32 v16, 12288
    v_mov_b32 v17, s3
    s_waitcnt vmcnt(4)
    s_mov_b64 exec, 1
    s_cmp_eq_u32 s44, 0
    s_cbranch_scc1 L_slow_17
    buffer_store_dword v17, v16, s[36:39], s5 offen
L_slow_17_j:
    s_mov_b64 exec, -1
    v_mfma_f32_32x32x16_bf16 v[144:159], a[204:207], v[164:167], v[144:159]
    v_rcp_f32 v202, v202
    v_mul_f32 v105, v105, v201
    s_add_u32 s53, s8, 4096
    buffer_load_dwordx4 v[48:51], v227, s[36:39], s53 offen offset:0 sc1
    s_waitcnt lgkmcnt(3)
    v_mfma_f32_32x32x16_bf16 v[128:143], a[208:211], v[168:171], v[128:143]
    ds_read_b128 v[188:191], v236 offset:64512
    v_exp_f32 v205, -v109
    v_mul_f32 v109, v109, v125
    v_fma_f32 v204, v204, s70, s70
    v_mfma_f32_32x32x16_bf16 v[144:159], a[212:215], v[168:171], v[144:159]
    v_rcp_f32 v203, v203
    v_mul_f32 v106, v106, v202
    v_cvt_pk_bf16_f32 v212, v104, v105
    buffer_load_dwordx4 v[52:55], v227, s[36:39], s53 offen offset:1024 sc1
    v_mfma_f32_32x32x16_bf16 v[128:143], a[216:219], v[172:175], v[128:143]
    v_exp_f32 v206, -v110
    v_mul_f32 v110, v110, v126
    v_fma_f32 v205, v205, s70, s70
    v_mfma_f32_32x32x16_bf16 v[144:159], a[220:223], v[172:175], v[144:159]
    v_rcp_f32 v204, v204
    v_mul_f32 v107, v107, v203
    buffer_load_dwordx4 v[56:59], v227, s[36:39], s53 offen offset:2048 sc1
    s_waitcnt lgkmcnt(2)
    v_mfma_f32_32x32x16_bf16 v[128:143], a[224:227], v[176:179], v[128:143]
    v_exp_f32 v207, -v111
    v_mul_f32 v111, v111, v127
    v_fma_f32 v206, v206, s70, s70
    v_mfma_f32_32x32x16_bf16 v[144:159], a[228:231], v[176:179], v[144:159]
    v_rcp_f32 v205, v205
    v_mul_f32 v108, v108, v204
    v_cvt_pk_bf16_f32 v213, v106, v107
    buffer_load_dwordx4 v[60:63], v227, s[36:39], s53 offen offset:3072 sc1
    v_mfma_f32_32x32x16_bf16 v[128:143], a[232:235], v[180:183], v[128:143]
    v_fma_f32 v207, v207, s70, s70
    v_rcp_f32 v206, v206
    v_mul_f32 v109, v109, v205
    v_mfma_f32_32x32x16_bf16 v[144:159], a[236:239], v[180:183], v[144:159]
    v_rcp_f32 v207, v207
    v_mul_f32 v110, v110, v206
    s_add_u32 s53, s8, 8192
    buffer_load_dwordx4 v[64:67], v227, s[36:39], s53 offen offset:0 sc1
    s_waitcnt lgkmcnt(0)
    v_mfma_f32_32x32x16_bf16 v[128:143], a[240:243], v[184:187], v[128:143]
    v_cvt_pk_bf16_f32 v214, v108, v109
    v_mul_f32 v111, v111, v207
    v_cvt_pk_bf16_f32 v215, v110, v111
    v_mfma_f32_32x32x16_bf16 v[144:159], a[244:247], v[184:187], v[144:159]
    s_add_u32 s49, s0, 229376
    buffer_store_dwordx4 v[208:211], v227, s[36:39], s49 offen sc1
    buffer_store_dwordx4 v[212:215], v227, s[36:39], s49 offen offset:1024 sc1
    buffer_load_dwordx4 v[68:71], v227, s[36:39], s53 offen offset:1024 sc1
    v_mfma_f32_32x32x16_bf16 v[128:143], a[248:251], v[188:191], v[128:143]
    v_mfma_f32_32x32x16_bf16 v[144:159], a[252:255], v[188:191], v[144:159]
    s_nop 7
    s_nop 3
    v_exp_f32 v192, -v128
    v_mul_f32 v128, v128, v144
    v_exp_f32 v193, -v129
    v_mul_f32 v129, v129, v145
    v_fma_f32 v192, v192, s70, s70
    v_exp_f32 v194, -v130
    v_mul_f32 v130, v130, v146
    v_fma_f32 v193, v193, s70, s70
    v_rcp_f32 v192, v192
    v_exp_f32 v195, -v131
    v_mul_f32 v131, v131, v147
    v_fma_f32 v194, v194, s70, s70
    v_rcp_f32 v193, v193
    v_mul_f32 v128, v128, v192
    v_exp_f32 v196, -v132
    v_mul_f32 v132, v132, v148
    v_fma_f32 v195, v195, s70, s70
    v_rcp_f32 v194, v194
    v_mul_f32 v129, v129, v193
    v_exp_f32 v197, -v133
    v_mul_f32 v133, v133, v149
    v_fma_f32 v196, v196, s70, s70
    v_rcp_f32 v195, v195
    v_mul_f32 v130, v130, v194
    v_cvt_pk_bf16_f32 v208, v128, v129
    v_exp_f32 v198, -v134
    v_mul_f32 v134, v134, v150
    v_fma_f32 v197, v197, s70, s70
    v_rcp_f32 v196, v196
    v_mul_f32 v131, v131, v195
    v_exp_f32 v199, -v135
    v_mul_f32 v135, v135, v151
    v_fma_f32 v198, v198, s70, s70
    v_rcp_f32 v197, v197
    v_mul_f32 v132, v132, v196
    v_cvt_pk_bf16_f32 v209, v130, v131
    v_exp_f32 v200, -v136
    v_mul_f32 v136, v136, v152
    v_fma_f32 v199, v199, s70, s70
    v_rcp_f32 v198, v198
    s_add_u32 s51, s71, 12288
    buffer_load_dword v19, v239, s[36:39], s51 offen sc1
    v_mul_f32 v133, v133, v197
    v_exp_f32 v201, -v137
    v_mul_f32 v137, v137, v153
    v_fma_f32 v200, v200, s70, s70
    v_rcp_f32 v199, v199
    v_mul_f32 v134, v134, v198
    v_cvt_pk_bf16_f32 v210, v132, v133
    v_exp_f32 v202, -v138
    v_mul_f32 v138, v138, v154
    v_fma_f32 v201, v201, s70, s70
    v_rcp_f32 v200, v200
    v_mul_f32 v135, v135, v199
    v_exp_f32 v203, -v139
    v_mul_f32 v139, v139, v155
    v_fma_f32 v202, v202, s70, s70
    v_rcp_f32 v201, v201
    v_mul_f32 v136, v136, v200
    v_cvt_pk_bf16_f32 v211, v134, v135
    v_exp_f32 v204, -v140
    v_mul_f32 v140, v140, v156
    v_fma_f32 v203, v203, s70, s70
    v_rcp_f32 v202, v202
    v_mul_f32 v137, v137, v201
    v_exp_f32 v205, -v141
    v_mul_f32 v141, v141, v157
    v_fma_f32 v204, v204, s70, s70
    v_rcp_f32 v203, v203
    v_mul_f32 v138, v138, v202
    v_cvt_pk_bf16_f32 v212, v136, v137
    v_exp_f32 v206, -v142
    v_mul_f32 v142, v142, v158
    v_fma_f32 v205, v205, s70, s70
    v_rcp_f32 v204, v204
    v_mul_f32 v139, v139, v203
    v_exp_f32 v207, -v143
    v_mul_f32 v143, v143, v159
    v_fma_f32 v206, v206, s70, s70
    v_rcp_f32 v205, v205
    v_mul_f32 v140, v140, v204
    v_cvt_pk_bf16_f32 v213, v138, v139
    v_fma_f32 v207, v207, s70, s70
    v_rcp_f32 v206, v206
    v_mul_f32 v141, v141, v205
    v_rcp_f32 v207, v207
    v_mul_f32 v142, v142, v206
    v_cvt_pk_bf16_f32 v214, v140, v141
    v_mul_f32 v143, v143, v207
    v_cvt_pk_bf16_f32 v215, v142, v143
    s_add_u32 s49, s0, 344064
    buffer_store_dwordx4 v[208:211], v227, s[36:39], s49 offen sc1
    buffer_store_dwordx4 v[212:215], v227, s[36:39], s49 offen offset:1024 sc1
L_p4:
    s_waitcnt lgkmcnt(0)
    s_waitcnt vmcnt(15)
    v_mfma_f32_32x32x16_bf16 v[96:111], a[0:3], v[32:35], 0
    buffer_load_dwordx4 v[72:75], v227, s[36:39], s53 offen offset:2048 sc1
    ds_read_b64_tr_b16 a[32:33], v6 offset:6144
    ds_read_b64_tr_b16 a[34:35], v6 offset:6656
    v_mfma_f32_32x32x16_bf16 v[112:127], a[4:7], v[32:35], 0
    v_mov_b32 v16, 24576
    v_mov_b32 v17, s3
    s_waitcnt vmcnt(5)
    s_mov_b64 exec, 1
    s_cmp_eq_u32 s44, 0
    s_cbranch_scc1 L_slow_18
    buffer_store_dword v17, v16, s[36:39], s5 offen
L_slow_18_j:
    s_mov_b64 exec, -1
    ds_read_b64_tr_b16 a[36:37], v7 offset:6144
    ds_read_b64_tr_b16 a[38:39], v7 offset:6656
    v_mfma_f32_32x32x16_bf16 v[96:111], a[8:11], v[36:39], v[96:111]
    buffer_load_dwordx4 v[76:79], v227, s[36:39], s53 offen offset:3072 sc1
    ds_read_b64_tr_b16 a[40:41], v27 offset:12288
    ds_read_b64_tr_b16 a[42:43], v27 offset:12800
    v_mfma_f32_32x32x16_bf16 v[112:127], a[12:15], v[36:39], v[112:127]
    ds_read_b64_tr_b16 a[44:45], v28 offset:12288
    ds_read_b64_tr_b16 a[46:47], v28 offset:12800
    v_mfma_f32_32x32x16_bf16 v[96:111], a[16:19], v[40:43], v[96:111]
    s_add_u32 s53, s8, 12288
    buffer_load_dwordx4 v[80:83], v227, s[36:39], s53 offen offset:0 sc1
    ds_read_b64_tr_b16 a[48:49], v8 offset:6144
    ds_read_b64_tr_b16 a[50:51], v8 offset:6656
    v_mfma_f32_32x32x16_bf16 v[112:127], a[20:23], v[40:43], v[112:127]
    ds_read_b64_tr_b16 a[52:53], v9 offset:6144
    ds_read_b64_tr_b16 a[54:55], v9 offset:6656
    v_mfma_f32_32x32x16_bf16 v[96:111], a[24:27], v[44:47], v[96:111]
    buffer_load_dwordx4 v[84:87], v227, s[36:39], s53 offen offset:1024 sc1
    ds_read_b64_tr_b16 a[56:57], v6 offset:0
    ds_read_b64_tr_b16 a[58:59], v6 offset:512
    v_mfma_f32_32x32x16_bf16 v[112:127], a[28:31], v[44:47], v[112:127]
    ds_read_b64_tr_b16 a[60:61], v7 offset:0
    ds_read_b64_tr_b16 a[62:63], v7 offset:512
    s_waitcnt vmcnt(7)
    v_cmp_ne_u32 vcc, s3, v19
    s_mov_b32 s55, 0
    s_and_b64 vcc, vcc, s[14:15]
    s_cbranch_vccnz L_poll_19
L_poll_19_ok:
    s_waitcnt lgkmcnt(12)
    v_mfma_f32_32x32x16_bf16 v[96:111], a[32:35], v[48:51], v[96:111]
    s_add_u32 s53, s9, 0
    buffer_load_dwordx4 v[88:91], v227, s[36:39], s53 offen offset:0 sc1
    ds_read_b64_tr_b16 a[64:65], v6 offset:2048
    ds_read_b64_tr_b16 a[66:67], v6 offset:2560
    v_mfma_f32_32x32x16_bf16 v[112:127], a[36:39], v[48:51], v[112:127]
    ds_read_b64_tr_b16 a[68:69], v7 offset:2048
    ds_read_b64_tr_b16 a[70:71], v7 offset:2560
    s_waitcnt lgkmcnt(12)
    v_mfma_f32_32x32x16_bf16 v[96:111], a[40:43], v[52:55], v[96:111]
    buffer_load_dwordx4 v[92:95], v227, s[36:39], s53 offen offset:1024 sc1
    ds_read_b64_tr_b16 a[72:73], v8 offset:0
    ds_read_b64_tr_b16 a[74:75], v8 offset:512
    v_mfma_f32_32x32x16_bf16 v[112:127], a[44:47], v[52:55], v[112:127]
    ds_read_b64_tr_b16 a[76:77], v9 offset:0
    ds_read_b64_tr_b16 a[78:79], v9 offset:512
    s_waitcnt lgkmcnt(12)
    v_mfma_f32_32x32x16_bf16 v[96:111], a[48:51], v[56:59], v[96:111]
    buffer_load_dwordx4 v[32:35], v227, s[36:39], s53 offen offset:2048 sc1
    v_mov_b32 v16, 32768
    v_mov_b32 v17, s3
    s_waitcnt vmcnt(8)
    s_mov_b64 exec, 1
    s_cmp_eq_u32 s44, 0
    s_cbranch_scc1 L_slow_20
    buffer_store_dword v17, v16, s[36:39], s5 offen
L_slow_20_j:
    s_mov_b64 exec, -1
    ds_read_b64_tr_b16 a[80:81], v8 offset:2048
    ds_read_b64_tr_b16 a[82:83], v8 offset:2560
    v_mfma_f32_32x32x16_bf16 v[112:127], a[52:55], v[56:59], v[112:127]
    ds_read_b64_tr_b16 a[84:85], v9 offset:2048
    ds_read_b64_tr_b16 a[86:87], v9 offset:2560
    s_waitcnt lgkmcnt(12)
    v_mfma_f32_32x32x16_bf16 v[96:111], a[56:59], v[60:63], v[96:111]
    buffer_load_dwordx4 v[36:39], v227, s[36:39], s53 offen offset:3072 sc1
    ds_read_b64_tr_b16 a[88:89], v6 offset:8192
    ds_read_b64_tr_b16 a[90:91], v6 offset:8704
    v_mfma_f32_32x32x16_bf16 v[112:127], a[60:63], v[60:63], v[112:127]
    ds_read_b64_tr_b16 a[92:93], v7 offset:8192
    ds_read_b64_tr_b16 a[94:95], v7 offset:8704
    s_waitcnt lgkmcnt(12)
    v_mfma_f32_32x32x16_bf16 v[96:111], a[64:67], v[64:67], v[96:111]
    s_add_u32 s53, s9, 4096
    buffer_load_dwordx4 v[40:43], v227, s[36:39], s53 offen offset:0 sc1
    ds_read_b64_tr_b16 a[96:97], v6 offset:10240
    ds_read_b64_tr_b16 a[98:99], v6 offset:10752
    v_mfma_f32_32x32x16_bf16 v[112:127], a[68:71], v[64:67], v[112:127]
    ds_read_b64_tr_b16 a[100:101], v7 offset:10240
    ds_read_b64_tr_b16 a[102:103], v7 offset:10752
    s_add_u32 s51, s71, 24576
    buffer_load_dword v18, v239, s[36:39], s51 offen sc1
    s_waitcnt lgkmcnt(12)
    v_mfma_f32_32x32x16_bf16 v[96:111], a[72:75], v[68:71], v[96:111]
    buffer_load_dwordx4 v[44:47], v227, s[36:39], s53 offen offset:1024 sc1
    ds_read_b64_tr_b16 a[104:105], v8 offset:4096
    ds_read_b64_tr_b16 a[106:107], v8 offset:4608
    v_mfma_f32_32x32x16_bf16 v[112:127], a[76:79], v[68:71], v[112:127]
    ds_read_b64_tr_b16 a[108:109], v9 offset:4096
    ds_read_b64_tr_b16 a[110:111], v9 offset:4608
    s_waitcnt vmcnt(12)
    s_waitcnt lgkmcnt(12)
    v_mfma_f32_32x32x16_bf16 v[96:111], a[80:83], v[72:75], v[96:111]
    buffer_load_dwordx4 v[48:51], v227, s[36:39], s53 offen offset:2048 sc1
    v_mfma_f32_32x32x16_bf16 v[112:127], a[84:87], v[72:75], v[112:127]
    s_waitcnt vmcnt(11)
    s_waitcnt lgkmcnt(8)
    v_mfma_f32_32x32x16_bf16 v[96:111], a[88:91], v[76:79], v[96:111]
    buffer_load_dwordx4 v[52:55], v227, s[36:39], s53 offen offset:3072 sc1
    v_mfma_f32_32x32x16_bf16 v[112:127], a[92:95], v[76:79], v[112:127]
    s_waitcnt vmcnt(11)
    s_waitcnt lgkmcnt(4)
    v_mfma_f32_32x32x16_bf16 v[96:111], a[96:99], v[80:83], v[96:111]
    s_add_u32 s53, s9, 8192
    buffer_load_dwordx4 v[56:59], v227, s[36:39], s53 offen offset:0 sc1
    v_mfma_f32_32x32x16_bf16 v[112:127], a[100:103], v[80:83], v[112:127]
    s_waitcnt vmcnt(11)
    s_waitcnt lgkmcnt(0)
    v_mfma_f32_32x32x16_bf16 v[96:111], a[104:107], v[84:87], v[96:111]
    buffer_load_dwordx4 v[60:63], v227, s[36:39], s53 offen offset:1024 sc1
    v_mfma_f32_32x32x16_bf16 v[112:127], a[108:111], v[84:87], v[112:127]
    s_waitcnt vmcnt(11)
    v_mfma_f32_32x32x16_bf16 v[128:143], a[0:3], v[88:91], 0
    buffer_load_dwordx4 v[64:67], v227, s[36:39], s53 offen offset:2048 sc1
    v_mfma_f32_32x32x16_bf16 v[144:159], a[4:7], v[88:91], 0
    s_waitcnt vmcnt(11)
    v_mfma_f32_32x32x16_bf16 v[128:143], a[8:11], v[92:95], v[128:143]
    buffer_load_dwordx4 v[68:71], v227, s[36:39], s53 offen offset:3072 sc1
    s_barrier
    v_mfma_f32_32x32x16_bf16 v[144:159], a[12:15], v[92:95], v[144:159]
    s_waitcnt vmcnt(11)
    v_mfma_f32_32x32x16_bf16 v[128:143], a[16:19], v[32:35], v[128:143]
    s_add_u32 s53, s9, 12288
    buffer_load_dwordx4 v[72:75], v227, s[36:39], s53 offen offset:0 sc1
    ds_write_b128 v228, v[104:107] offset:0
    v_mfma_f32_32x32x16_bf16 v[144:159], a[20:23], v[32:35], v[144:159]
    ds_write_b128 v228, v[108:111] offset:1024
    s_waitcnt vmcnt(10)
    v_mfma_f32_32x32x16_bf16 v[128:143], a[24:27], v[36:39], v[128:143]
    buffer_load_dwordx4 v[76:79], v227, s[36:39], s53 offen offset:1024 sc1
    v_mfma_f32_32x32x16_bf16 v[144:159], a[28:31], v[36:39], v[144:159]
    ds_write_b128 v229, v[112:115] offset:0
    s_waitcnt vmcnt(9)
    v_cmp_ne_u32 vcc, s3, v18
    s_mov_b32 s55, 0
    s_and_b64 vcc, vcc, s[14:15]
    s_cbranch_vccnz L_poll_21
L_poll_21_ok:
    v_mfma_f32_32x32x16_bf16 v[128:143], a[32:35], v[40:43], v[128:143]
    s_add_u32 s53, s10, 0
    buffer_load_dwordx4 v[80:83], v227, s[36:39], s53 offen offset:0 sc1
    ds_write_b128 v229, v[116:119] offset:1024
    v_mfma_f32_32x32x16_bf16 v[144:159], a[36:39], v[40:43], v[144:159]
    s_waitcnt vmcnt(9)
    v_mfma_f32_32x32x16_bf16 v[128:143], a[40:43], v[44:47], v[128:143]
    buffer_load_dwordx4 v[84:87], v227, s[36:39], s53 offen offset:1024 sc1
    ds_write_b128 v230, v[120:123] offset:0
    v_mfma_f32_32x32x16_bf16 v[144:159], a[44:47], v[44:47], v[144:159]
    ds_write_b128 v230, v[124:127] offset:1024
    s_waitcnt vmcnt(9)
    v_mfma_f32_32x32x16_bf16 v[128:143], a[48:51], v[48:51], v[128:143]
    buffer_load_dwordx4 v[88:91], v227, s[36:39], s53 offen offset:2048 sc1
    v_mfma_f32_32x32x16_bf16 v[144:159], a[52:55], v[48:51], v[144:159]
    s_waitcnt vmcnt(9)
    v_mfma_f32_32x32x16_bf16 v[128:143], a[56:59], v[52:55], v[128:143]
    buffer_load_dwordx4 v[92:95], v227, s[36:39], s53 offen offset:3072 sc1
    s_waitcnt lgkmcnt(0)
    s_barrier
    ds_read_b128 v[104:107], v231 offset:0
    v_mfma_f32_32x32x16_bf16 v[144:159], a[60:63], v[52:55], v[144:159]
    ds_read_b128 v[108:111], v231 offset:1024
    ds_read_b128 v[112:115], v231 offset:2048
    s_add_u32 s51, s71, 32768
    buffer_load_dword v19, v239, s[36:39], s51 offen sc1
    s_waitcnt vmcnt(10)
    v_mfma_f32_32x32x16_bf16 v[128:143], a[64:67], v[56:59], v[128:143]
    s_add_u32 s53, s10, 4096
    buffer_load_dwordx4 v[32:35], v227, s[36:39], s53 offen offset:0 sc1
    ds_read_b128 v[116:119], v231 offset:3072
    ds_read_b128 v[120:123], v231 offset:4096
    v_mfma_f32_32x32x16_bf16 v[144:159], a[68:71], v[56:59], v[144:159]
    ds_read_b128 v[124:127], v231 offset:5120
    s_waitcnt vmcnt(10)
    v_mfma_f32_32x32x16_bf16 v[128:143], a[72:75], v[60:63], v[128:143]
    buffer_load_dwordx4 v[36:39], v227, s[36:39], s53 offen offset:1024 sc1
    v_mfma_f32_32x32x16_bf16 v[144:159], a[76:79], v[60:63], v[144:159]
    s_waitcnt lgkmcnt(0)
    v_add_f32 v96, v96, v104
    v_add_f32 v97, v97, v105
    v_add_f32 v112, v112, v120
    s_waitcnt vmcnt(10)
    v_mfma_f32_32x32x16_bf16 v[128:143], a[80:83], v[64:67], v[128:143]
    buffer_load_dwordx4 v[40:43], v227, s[36:39], s53 offen offset:2048 sc1
    v_add_f32 v113, v113, v121
    v_add_f32 v98, v98, v106
    v_add_f32 v99, v99, v107
    v_add_f32 v114, v114, v122
    v_mfma_f32_32x32x16_bf16 v[144:159], a[84:87], v[64:67], v[144:159]
    v_add_f32 v115, v115, v123
    v_add_f32 v100, v100, v108
    v_add_f32 v101, v101, v109
    v_add_f32 v116, v116, v124
    s_waitcnt vmcnt(10)
    v_mfma_f32_32x32x16_bf16 v[128:143], a[88:91], v[68:71], v[128:143]
    buffer_load_dwordx4 v[44:47], v227, s[36:39], s53 offen offset:3072 sc1
    v_add_f32 v117, v117, v125
    v_add_f32 v102, v102, v110
    v_add_f32 v103, v103, v111
    v_add_f32 v118, v118, v126
    v_mfma_f32_32x32x16_bf16 v[144:159], a[92:95], v[68:71], v[144:159]
    v_add_f32 v119, v119, v127
    v_add_f32 v96, v96, v112
    v_add_f32 v97, v97, v113
    v_add_f32 v98, v98, v114
    s_waitcnt vmcnt(10)
    v_mfma_f32_32x32x16_bf16 v[128:143], a[96:99], v[72:75], v[128:143]
    s_add_u32 s53, s10, 8192
    buffer_load_dwordx4 v[48:51], v227, s[36:39], s53 offen offset:0 sc1
    v_add_f32 v99, v99, v115
    v_add_f32 v100, v100, v116
    v_add_f32 v101, v101, v117
    v_add_f32 v102, v102, v118
    v_mfma_f32_32x32x16_bf16 v[144:159], a[100:103], v[72:75], v[144:159]
    v_add_f32 v103, v103, v119
    s_waitcnt vmcnt(10)
    v_mfma_f32_32x32x16_bf16 v[128:143], a[104:107], v[76:79], v[128:143]
    buffer_load_dwordx4 v[52:55], v227, s[36:39], s53 offen offset:1024 sc1
    v_cvt_pk_bf16_f32 v104, v96, v97
    v_cvt_pk_bf16_f32 v105, v98, v99
    v_cvt_pk_bf16_f32 v106, v100, v101
    v_cvt_pk_bf16_f32 v107, v102, v103
    buffer_store_dwordx4 v[104:107], v227, s[36:39], s18 offen sc1
    v_mfma_f32_32x32x16_bf16 v[144:159], a[108:111], v[76:79], v[144:159]
    s_waitcnt vmcnt(11)
    v_mfma_f32_32x32x16_bf16 v[160:175], a[0:3], v[80:83], 0
    buffer_load_dwordx4 v[56:59], v227, s[36:39], s53 offen offset:2048 sc1
    v_mfma_f32_32x32x16_bf16 v[176:191], a[4:7], v[80:83], 0
    s_waitcnt vmcnt(11)
    v_mfma_f32_32x32x16_bf16 v[160:175], a[8:11], v[84:87], v[160:175]
    buffer_load_dwordx4 v[60:63], v227, s[36:39], s53 offen offset:3072 sc1
    v_mfma_f32_32x32x16_bf16 v[176:191], a[12:15], v[84:87], v[176:191]
    ds_write_b128 v228, v[136:139] offset:6144
    s_waitcnt vmcnt(11)
    v_mfma_f32_32x32x16_bf16 v[160:175], a[16:19], v[88:91], v[160:175]
    s_add_u32 s53, s10, 12288
    buffer_load_dwordx4 v[64:67], v227, s[36:39], s53 offen offset:0 sc1
    ds_write_b128 v228, v[140:143] offset:7168
    v_mfma_f32_32x32x16_bf16 v[176:191], a[20:23], v[88:91], v[176:191]
    ds_write_b128 v229, v[144:147] offset:6144
    s_waitcnt vmcnt(11)
    v_mfma_f32_32x32x16_bf16 v[160:175], a[24:27], v[92:95], v[160:175]
    buffer_load_dwordx4 v[68:71], v227, s[36:39], s53 offen offset:1024 sc1
    ds_write_b128 v229, v[148:151] offset:7168
    v_mfma_f32_32x32x16_bf16 v[176:191], a[28:31], v[92:95], v[176:191]
    ds_write_b128 v230, v[152:155] offset:6144
    s_waitcnt vmcnt(11)
    v_cmp_ne_u32 vcc, s3, v19
    s_mov_b32 s55, 0
    s_and_b64 vcc, vcc, s[14:15]
    s_cbranch_vccnz L_poll_22
L_poll_22_ok:
    s_waitcnt vmcnt(10)
    v_mfma_f32_32x32x16_bf16 v[160:175], a[32:35], v[32:35], v[160:175]
    s_add_u32 s53, s11, 0
    buffer_load_dwordx4 v[72:75], v227, s[36:39], s53 offen offset:0 sc1
    ds_write_b128 v230, v[156:159] offset:7168
    v_mfma_f32_32x32x16_bf16 v[176:191], a[36:39], v[32:35], v[176:191]
    s_waitcnt vmcnt(10)
    v_mfma_f32_32x32x16_bf16 v[160:175], a[40:43], v[36:39], v[160:175]
    buffer_load_dwordx4 v[76:79], v227, s[36:39], s53 offen offset:1024 sc1
    s_waitcnt lgkmcnt(0)
    s_barrier
    ds_read_b128 v[136:139], v231 offset:6144
    ds_read_b128 v[140:143], v231 offset:7168
    v_mfma_f32_32x32x16_bf16 v[176:191], a[44:47], v[36:39], v[176:191]
    ds_read_b128 v[144:147], v231 offset:8192
    ds_read_b128 v[148:151], v231 offset:9216
    ds_read_b128 v[152:155], v231 offset:10240
    s_waitcnt vmcnt(10)
    v_mfma_f32_32x32x16_bf16 v[160:175], a[48:51], v[40:43], v[160:175]
    buffer_load_dwordx4 v[80:83], v227, s[36:39], s53 offen offset:2048 sc1
    ds_read_b128 v[156:159], v231 offset:11264
    v_mfma_f32_32x32x16_bf16 v[176:191], a[52:55], v[40:43], v[176:191]
    s_waitcnt vmcnt(10)
    v_mfma_f32_32x32x16_bf16 v[160:175], a[56:59], v[44:47], v[160:175]
    buffer_load_dwordx4 v[84:87], v227, s[36:39], s53 offen offset:3072 sc1
    s_waitcnt lgkmcnt(0)
    v_add_f32 v128, v128, v136
    v_add_f32 v129, v129, v137
    v_add_f32 v144, v144, v152
    v_mfma_f32_32x32x16_bf16 v[176:191], a[60:63], v[44:47], v[176:191]
    v_add_f32 v145, v145, v153
    v_add_f32 v130, v130, v138
    v_add_f32 v131, v131, v139
    v_add_f32 v146, v146, v154
    s_waitcnt vmcnt(10)
    v_mfma_f32_32x32x16_bf16 v[160:175], a[64:67], v[48:51], v[160:175]
    s_add_u32 s53, s11, 4096
    buffer_load_dwordx4 v[88:91], v227, s[36:39], s53 offen offset:0 sc1
    v_add_f32 v147, v147, v155
    v_add_f32 v132, v132, v140
    v_add_f32 v133, v133, v141
    v_add_f32 v148, v148, v156
    v_mfma_f32_32x32x16_bf16 v[176:191], a[68:71], v[48:51], v[176:191]
    v_add_f32 v149, v149, v157
    v_add_f32 v134, v134, v142
    v_add_f32 v135, v135, v143
    v_add_f32 v150, v150, v158
    s_waitcnt vmcnt(10)
    v_mfma_f32_32x32x16_bf16 v[160:175], a[72:75], v[52:55], v[160:175]
    buffer_load_dwordx4 v[92:95], v227, s[36:39], s53 offen offset:1024 sc1
    v_add_f32 v151, v151, v159
    v_add_f32 v128, v128, v144
    v_add_f32 v129, v129, v145
    v_add_f32 v130, v130, v146
    v_mfma_f32_32x32x16_bf16 v[176:191], a[76:79], v[52:55], v[176:191]
    v_add_f32 v131, v131, v147
    v_add_f32 v132, v132, v148
    v_add_f32 v133, v133, v149
    v_add_f32 v134, v134, v150
    s_waitcnt vmcnt(9)
    v_mfma_f32_32x32x16_bf16 v[160:175], a[80:83], v[56:59], v[160:175]
    buffer_load_dwordx4 v[32:35], v227, s[36:39], s53 offen offset:2048 sc1
    v_add_f32 v135, v135, v151
    v_mfma_f32_32x32x16_bf16 v[176:191], a[84:87], v[56:59], v[176:191]
    v_cvt_pk_bf16_f32 v136, v128, v129
    v_cvt_pk_bf16_f32 v137, v130, v131
    v_cvt_pk_bf16_f32 v138, v132, v133
    v_cvt_pk_bf16_f32 v139, v134, v135
    buffer_store_dwordx4 v[136:139], v13, s[36:39], s18 offen sc1
    s_waitcnt vmcnt(10)
    v_mfma_f32_32x32x16_bf16 v[160:175], a[88:91], v[60:63], v[160:175]
    buffer_load_dwordx4 v[36:39], v227, s[36:39], s53 offen offset:3072 sc1
    v_mfma_f32_32x32x16_bf16 v[176:191], a[92:95], v[60:63], v[176:191]
    s_waitcnt vmcnt(10)
    v_mfma_f32_32x32x16_bf16 v[160:175], a[96:99], v[64:67], v[160:175]
    s_add_u32 s53, s11, 8192
    buffer_load_dwordx4 v[40:43], v227, s[36:39], s53 offen offset:0 sc1
    v_mfma_f32_32x32x16_bf16 v[176:191], a[100:103], v[64:67], v[176:191]
    s_waitcnt vmcnt(10)
    v_mfma_f32_32x32x16_bf16 v[160:175], a[104:107], v[68:71], v[160:175]
    buffer_load_dwordx4 v[44:47], v227, s[36:39], s53 offen offset:1024 sc1
    v_mfma_f32_32x32x16_bf16 v[176:191], a[108:111], v[68:71], v[176:191]
    s_waitcnt vmcnt(10)
    v_mfma_f32_32x32x16_bf16 v[192:207], a[0:3], v[72:75], 0
    buffer_load_dwordx4 v[48:51], v227, s[36:39], s53 offen offset:2048 sc1
    v_mfma_f32_32x32x16_bf16 v[208:223], a[4:7], v[72:75], 0
    s_waitcnt vmcnt(10)
    v_mfma_f32_32x32x16_bf16 v[192:207], a[8:11], v[76:79], v[192:207]
    buffer_load_dwordx4 v[52:55], v227, s[36:39], s53 offen offset:3072 sc1
    v_mfma_f32_32x32x16_bf16 v[208:223], a[12:15], v[76:79], v[208:223]
    s_waitcnt vmcnt(10)
    v_mfma_f32_32x32x16_bf16 v[192:207], a[16:19], v[80:83], v[192:207]
    s_add_u32 s53, s11, 12288
    buffer_load_dwordx4 v[56:59], v227, s[36:39], s53 offen offset:0 sc1
    ds_write_b128 v228, v[168:171] offset:12288
    v_mfma_f32_32x32x16_bf16 v[208:223], a[20:23], v[80:83], v[208:223]
    ds_write_b128 v228, v[172:175] offset:13312
    s_waitcnt vmcnt(10)
    v_mfma_f32_32x32x16_bf16 v[192:207], a[24:27], v[84:87], v[192:207]
    buffer_load_dwordx4 v[60:63], v227, s[36:39], s53 offen offset:1024 sc1
    ds_write_b128 v229, v[176:179] offset:12288
    v_mfma_f32_32x32x16_bf16 v[208:223], a[28:31], v[84:87], v[208:223]
    ds_write_b128 v229, v[180:183] offset:13312
    s_waitcnt vmcnt(10)
    v_mfma_f32_32x32x16_bf16 v[192:207], a[32:35], v[88:91], v[192:207]
    ds_write_b128 v230, v[184:187] offset:12288
    v_mfma_f32_32x32x16_bf16 v[208:223], a[36:39], v[88:91], v[208:223]
    ds_write_b128 v230, v[188:191] offset:13312
    s_waitcnt vmcnt(9)
    v_mfma_f32_32x32x16_bf16 v[192:207], a[40:43], v[92:95], v[192:207]
    v_mov_b32 v16, 16384
    v_mov_b32 v17, s3
    s_waitcnt vmcnt(7)
    s_mov_b64 exec, 1
    s_cmp_eq_u32 s44, 0
    s_cbranch_scc1 L_slow_23
    buffer_store_dword v17, v16, s[36:39], s5 offen
L_slow_23_j:
    s_mov_b64 exec, -1
    v_mfma_f32_32x32x16_bf16 v[208:223], a[44:47], v[92:95], v[208:223]
    v_mfma_f32_32x32x16_bf16 v[192:207], a[48:51], v[32:35], v[192:207]
    s_waitcnt lgkmcnt(0)
    s_barrier
    ds_read_b128 v[168:171], v231 offset:12288
    ds_read_b128 v[172:175], v231 offset:13312
    v_mfma_f32_32x32x16_bf16 v[208:223], a[52:55], v[32:35], v[208:223]
    ds_read_b128 v[176:179], v231 offset:14336
    ds_read_b128 v[180:183], v231 offset:15360
    ds_read_b128 v[184:187], v231 offset:16384
    s_waitcnt vmcnt(7)
    v_mfma_f32_32x32x16_bf16 v[192:207], a[56:59], v[36:39], v[192:207]
    ds_read_b128 v[188:191], v231 offset:17408
    v_mfma_f32_32x32x16_bf16 v[208:223], a[60:63], v[36:39], v[208:223]
    s_waitcnt vmcnt(6)
    v_mfma_f32_32x32x16_bf16 v[192:207], a[64:67], v[40:43], v[192:207]
    s_waitcnt lgkmcnt(0)
    v_add_f32 v160, v160, v168
    v_add_f32 v161, v161, v169
    v_add_f32 v176, v176, v184
    s_add_u32 s51, s71, 16384
    buffer_load_dword v18, v239, s[36:39], s51 offen sc1
    v_mfma_f32_32x32x16_bf16 v[208:223], a[68:71], v[40:43], v[208:223]
    v_add_f32 v177, v177, v185
    v_add_f32 v162, v162, v170
    v_add_f32 v163, v163, v171
    v_add_f32 v178, v178, v186
    s_waitcnt vmcnt(6)
    v_mfma_f32_32x32x16_bf16 v[192:207], a[72:75], v[44:47], v[192:207]
    v_add_f32 v179, v179, v187
    v_add_f32 v164, v164, v172
    v_add_f32 v165, v165, v173
    v_add_f32 v180, v180, v188
    v_mfma_f32_32x32x16_bf16 v[208:223], a[76:79], v[44:47], v[208:223]
    v_add_f32 v181, v181, v189
    v_add_f32 v166, v166, v174
    v_add_f32 v167, v167, v175
    v_add_f32 v182, v182, v190
    s_waitcnt vmcnt(5)
    v_mfma_f32_32x32x16_bf16 v[192:207], a[80:83], v[48:51], v[192:207]
    v_add_f32 v183, v183, v191
    v_add_f32 v160, v160, v176
    v_add_f32 v161, v161, v177
    v_add_f32 v162, v162, v178
    v_mfma_f32_32x32x16_bf16 v[208:223], a[84:87], v[48:51], v[208:223]
    v_add_f32 v163, v163, v179
    v_add_f32 v164, v164, v180
    v_add_f32 v165, v165, v181
    v_add_f32 v166, v166, v182
    s_waitcnt vmcnt(4)
    v_mfma_f32_32x32x16_bf16 v[192:207], a[88:91], v[52:55], v[192:207]
    v_add_f32 v167, v167, v183
    s_waitcnt vmcnt(0)
    v_cmp_ne_u32 vcc, s3, v18
    s_mov_b32 s55, 0
    s_and_b64 vcc, vcc, s[16:17]
    s_cbranch_vccnz L_poll_24
L_poll_24_ok:
    buffer_load_dwordx4 v[240:243], v227, s[36:39], s19 offen sc1
    buffer_load_dwordx4 v[244:247], v13, s[36:39], s19 offen sc1
    v_mfma_f32_32x32x16_bf16 v[208:223], a[92:95], v[52:55], v[208:223]
    v_lshlrev_b32 v168, 16, v248
    v_and_b32 v169, 0xffff0000, v248
    v_lshlrev_b32 v170, 16, v249
    v_and_b32 v171, 0xffff0000, v249
    v_mfma_f32_32x32x16_bf16 v[192:207], a[96:99], v[56:59], v[192:207]
    v_lshlrev_b32 v172, 16, v250
    v_and_b32 v173, 0xffff0000, v250
    v_lshlrev_b32 v174, 16, v251
    v_and_b32 v175, 0xffff0000, v251
    v_mfma_f32_32x32x16_bf16 v[208:223], a[100:103], v[56:59], v[208:223]
    v_add_f32 v160, v160, v168
    v_add_f32 v161, v161, v169
    v_add_f32 v162, v162, v170
    v_add_f32 v163, v163, v171
    v_mfma_f32_32x32x16_bf16 v[192:207], a[104:107], v[60:63], v[192:207]
    v_add_f32 v164, v164, v172
    v_add_f32 v165, v165, v173
    v_add_f32 v166, v166, v174
    v_add_f32 v167, v167, v175
    v_mfma_f32_32x32x16_bf16 v[208:223], a[108:111], v[60:63], v[208:223]
    s_nop 1
    v_lshlrev_b32 v32, 16, v252
    v_and_b32 v33, 0xffff0000, v252
    v_lshlrev_b32 v34, 16, v253
    v_and_b32 v35, 0xffff0000, v253
    v_lshlrev_b32 v36, 16, v254
    v_and_b32 v37, 0xffff0000, v254
    v_lshlrev_b32 v38, 16, v255
    v_and_b32 v39, 0xffff0000, v255
    s_nop 1
    ds_write_b128 v228, v[200:203] offset:18432
    ds_write_b128 v228, v[204:207] offset:19456
    ds_write_b128 v229, v[208:211] offset:18432
    ds_write_b128 v229, v[212:215] offset:19456
    ds_write_b128 v230, v[216:219] offset:18432
    ds_write_b128 v230, v[220:223] offset:19456
    s_waitcnt vmcnt(0)
    v_lshlrev_b32 v40, 16, v244
    v_and_b32 v41, 0xffff0000, v244
    v_lshlrev_b32 v42, 16, v245
    v_and_b32 v43, 0xffff0000, v245
    v_lshlrev_b32 v44, 16, v246
    v_and_b32 v45, 0xffff0000, v246
    v_lshlrev_b32 v46, 16, v247
    v_and_b32 v47, 0xffff0000, v247
    v_pk_add_f32 v[32:33], v[32:33], v[40:41]
    v_pk_add_f32 v[34:35], v[34:35], v[42:43]
    v_pk_add_f32 v[36:37], v[36:37], v[44:45]
    v_pk_add_f32 v[38:39], v[38:39], v[46:47]
    s_waitcnt lgkmcnt(0)
    s_barrier
    ds_read_b128 v[200:203], v231 offset:18432
    ds_read_b128 v[204:207], v231 offset:19456
    ds_read_b128 v[208:211], v231 offset:20480
    ds_read_b128 v[212:215], v231 offset:21504
    ds_read_b128 v[216:219], v231 offset:22528
    ds_read_b128 v[220:223], v231 offset:23552
    v_lshlrev_b32 v168, 16, v240
    v_and_b32 v169, 0xffff0000, v240
    v_lshlrev_b32 v170, 16, v241
    v_and_b32 v171, 0xffff0000, v241
    v_lshlrev_b32 v172, 16, v242
    v_and_b32 v173, 0xffff0000, v242
    v_lshlrev_b32 v174, 16, v243
    v_and_b32 v175, 0xffff0000, v243
    v_pk_add_f32 v[160:161], v[160:161], v[168:169]
    v_pk_add_f32 v[162:163], v[162:163], v[170:171]
    v_pk_add_f32 v[164:165], v[164:165], v[172:173]
    v_pk_add_f32 v[166:167], v[166:167], v[174:175]
    v_cvt_pk_bf16_f32 v168, v160, v161
    v_cvt_pk_bf16_f32 v169, v162, v163
    v_cvt_pk_bf16_f32 v170, v164, v165
    v_cvt_pk_bf16_f32 v171, v166, v167
    buffer_store_dwordx4 v[168:171], v11, s[32:35], 0 offen sc0
    s_waitcnt lgkmcnt(0)
    v_pk_add_f32 v[192:193], v[192:193], v[200:201]
    v_pk_add_f32 v[208:209], v[208:209], v[216:217]
    v_pk_add_f32 v[194:195], v[194:195], v[202:203]
    v_pk_add_f32 v[210:211], v[210:211], v[218:219]
    v_pk_add_f32 v[196:197], v[196:197], v[204:205]
    v_pk_add_f32 v[212:213], v[212:213], v[220:221]
    v_pk_add_f32 v[198:199], v[198:199], v[206:207]
    v_pk_add_f32 v[214:215], v[214:215], v[222:223]
    v_pk_add_f32 v[192:193], v[192:193], v[208:209]
    v_pk_add_f32 v[194:195], v[194:195], v[210:211]
    v_pk_add_f32 v[196:197], v[196:197], v[212:213]
    v_pk_add_f32 v[198:199], v[198:199], v[214:215]
    v_pk_add_f32 v[192:193], v[192:193], v[32:33]
    v_pk_add_f32 v[194:195], v[194:195], v[34:35]
    v_pk_add_f32 v[196:197], v[196:197], v[36:37]
    v_pk_add_f32 v[198:199], v[198:199], v[38:39]
    v_cvt_pk_bf16_f32 v200, v192, v193
    v_cvt_pk_bf16_f32 v201, v194, v195
    v_cvt_pk_bf16_f32 v202, v196, v197
    v_cvt_pk_bf16_f32 v203, v198, v199
    s_mov_b32 s49, 32768
    buffer_store_dwordx4 v[200:203], v11, s[32:35], s49 offen sc0
L_done:
    s_endpgm
L_idle3:
    s_cmp_ge_u32 s46, 14
    s_cbranch_scc1 L_iw_25
L_iw_25_j:
    s_and_b32 s49, s45, 1
    s_lshl_b32 s49, s49, 1
    s_and_b32 s50, s46, 1
    s_add_u32 s49, s49, s50
    s_mul_i32 s49, s49, 458752
    s_lshl_b32 s50, s42, 13
    s_add_u32 s49, s49, s50
    s_min_u32 s50, s43, 6
    s_lshl_b32 s50, s50, 16
    s_add_u32 s50, s50, s49
    buffer_load_dword v3, v2, s[28:31], s50 offen
    s_add_u32 s50, s50, 32768
    buffer_load_dword v3, v2, s[28:31], s50 offen
    v_lshlrev_b32 v21, 10, v1
    s_mul_i32 s50, s42, 106496
    s_add_u32 s50, s50, s49
    s_waitcnt vmcnt(0)
    buffer_load_dword v3, v21, s[28:31], s50 offen offset:384
    s_add_u32 s50, s50, 57344
    buffer_load_dword v3, v21, s[28:31], s50 offen offset:384
    s_waitcnt lgkmcnt(0)
    s_barrier
    s_add_u32 m0, s68, 0
    s_add_u32 s54, s67, 0
    buffer_load_dwordx4 v226, s[28:31], s54 offen lds
    buffer_load_dwordx4 v12, s[28:31], s54 offen offset:1024 lds
    s_add_u32 m0, s68, 2048
    s_add_u32 s54, s67, 16384
    buffer_load_dwordx4 v226, s[28:31], s54 offen lds
    buffer_load_dwordx4 v12, s[28:31], s54 offen offset:1024 lds
    s_add_u32 m0, s68, 4096
    s_add_u32 s54, s67, 32768
    buffer_load_dwordx4 v226, s[28:31], s54 offen lds
    buffer_load_dwordx4 v12, s[28:31], s54 offen offset:1024 lds
    s_add_u32 m0, s68, 6144
    s_add_u32 s54, s67, 49152
    buffer_load_dwordx4 v226, s[28:31], s54 offen lds
    buffer_load_dwordx4 v12, s[28:31], s54 offen offset:1024 lds
    s_waitcnt vmcnt(6)
    ds_read_b64_tr_b16 a[0:1], v6 offset:0
    ds_read_b64_tr_b16 a[2:3], v6 offset:512
    ds_read_b64_tr_b16 a[4:5], v7 offset:0
    ds_read_b64_tr_b16 a[6:7], v7 offset:512
    s_waitcnt vmcnt(4)
    ds_read_b64_tr_b16 a[8:9], v6 offset:2048
    ds_read_b64_tr_b16 a[10:11], v6 offset:2560
    ds_read_b64_tr_b16 a[12:13], v7 offset:2048
    ds_read_b64_tr_b16 a[14:15], v7 offset:2560
    s_waitcnt vmcnt(2)
    ds_read_b64_tr_b16 a[16:17], v6 offset:4096
    ds_read_b64_tr_b16 a[18:19], v6 offset:4608
    ds_read_b64_tr_b16 a[20:21], v7 offset:4096
    ds_read_b64_tr_b16 a[22:23], v7 offset:4608
    s_waitcnt vmcnt(0)
    ds_read_b64_tr_b16 a[24:25], v6 offset:6144
    ds_read_b64_tr_b16 a[26:27], v6 offset:6656
    ds_read_b64_tr_b16 a[28:29], v7 offset:6144
    ds_read_b64_tr_b16 a[30:31], v7 offset:6656
    s_waitcnt lgkmcnt(0)
    s_barrier
    s_add_u32 m0, s68, 6144
    s_add_u32 s54, s67, 65536
    buffer_load_dwordx4 v226, s[28:31], s54 offen lds
    buffer_load_dwordx4 v12, s[28:31], s54 offen offset:1024 lds
    s_add_u32 m0, s40, 12288
    s_add_u32 s54, s67, 81920
    buffer_load_dwordx4 v226, s[28:31], s54 offen lds
    buffer_load_dwordx4 v12, s[28:31], s54 offen offset:1024 lds
    s_add_u32 m0, s69, 6144
    s_add_u32 s54, s67, 98304
    buffer_load_dwordx4 v226, s[28:31], s54 offen lds
    buffer_load_dwordx4 v12, s[28:31], s54 offen offset:1024 lds
    s_add_u32 m0, s68, 0
    s_add_u32 s54, s67, 114688
    buffer_load_dwordx4 v226, s[28:31], s54 offen lds
    buffer_load_dwordx4 v12, s[28:31], s54 offen offset:1024 lds
    s_add_u32 m0, s68, 2048
    s_add_u32 s54, s67, 131072
    buffer_load_dwordx4 v226, s[28:31], s54 offen lds
    buffer_load_dwordx4 v12, s[28:31], s54 offen offset:1024 lds
    s_add_u32 m0, s69, 0
    s_add_u32 s54, s67, 147456
    buffer_load_dwordx4 v226, s[28:31], s54 offen lds
    buffer_load_dwordx4 v12, s[28:31], s54 offen offset:1024 lds
    s_add_u32 m0, s69, 2048
    s_add_u32 s54, s67, 163840
    buffer_load_dwordx4 v226, s[28:31], s54 offen lds
    buffer_load_dwordx4 v12, s[28:31], s54 offen offset:1024 lds
    s_add_u32 m0, s68, 8192
    s_add_u32 s54, s67, 180224
    buffer_load_dwordx4 v226, s[28:31], s54 offen lds
    buffer_load_dwordx4 v12, s[28:31], s54 offen offset:1024 lds
    s_add_u32 m0, s68, 10240
    s_add_u32 s54, s67, 196608
    buffer_load_dwordx4 v226, s[28:31], s54 offen lds
    buffer_load_dwordx4 v12, s[28:31], s54 offen offset:1024 lds
    s_add_u32 m0, s69, 4096
    s_add_u32 s54, s67, 212992
    buffer_load_dwordx4 v226, s[28:31], s54 offen lds
    buffer_load_dwordx4 v12, s[28:31], s54 offen offset:1024 lds
    s_add_u32 s51, s71, 8192
    buffer_load_dword v18, v239, s[36:39], s51 offen sc1
    s_waitcnt vmcnt(0)
    v_cmp_ne_u32 vcc, s3, v18
    s_mov_b32 s55, 0
    s_and_b64 vcc, vcc, s[14:15]
    s_cbranch_vccnz L_poll_26
L_poll_26_ok:
    s_add_u32 s53, s8, 0
    buffer_load_dwordx4 v[32:35], v227, s[36:39], s53 offen offset:0 sc1
    buffer_load_dwordx4 v[36:39], v227, s[36:39], s53 offen offset:1024 sc1
    buffer_load_dwordx4 v[40:43], v227, s[36:39], s53 offen offset:2048 sc1
    buffer_load_dwordx4 v[44:47], v227, s[36:39], s53 offen offset:3072 sc1
    s_add_u32 s53, s8, 4096
    buffer_load_dwordx4 v[48:51], v227, s[36:39], s53 offen offset:0 sc1
    buffer_load_dwordx4 v[52:55], v227, s[36:39], s53 offen offset:1024 sc1
    buffer_load_dwordx4 v[56:59], v227, s[36:39], s53 offen offset:2048 sc1
    buffer_load_dwordx4 v[60:63], v227, s[36:39], s53 offen offset:3072 sc1
    s_add_u32 s53, s8, 8192
    buffer_load_dwordx4 v[64:67], v227, s[36:39], s53 offen offset:0 sc1
    buffer_load_dwordx4 v[68:71], v227, s[36:39], s53 offen offset:1024 sc1
    s_add_u32 s51, s71, 12288
    buffer_load_dword v19, v239, s[36:39], s51 offen sc1
    s_waitcnt vmcnt(0)
    s_branch L_p4
L_nl_4:
    global_load_dword v211, v210, s[100:101] sc1
    s_add_u32 s55, s55, 1
    s_waitcnt vmcnt(0)
    v_readfirstlane_b32 s3, v211
    s_cmp_gt_u32 s55, 400000
    s_cbranch_scc1 L_nl_4_ok
    s_cmp_eq_u32 s3, 0
    s_cbranch_scc1 L_nl_4
    s_branch L_nl_4_ok
L_pst_6:
    buffer_load_dwordx2 v[212:213], v220, s[36:39], s53 offen sc1
    s_add_u32 s55, s55, 1
    s_cmp_gt_u32 s55, 400000
    s_waitcnt vmcnt(0)
    s_cbranch_scc1 L_pst_6_ok
    v_cmp_ne_u32 vcc, s3, v212
    s_cbranch_vccnz L_pst_6
    s_branch L_pst_6_ok
L_slow_7:
    buffer_store_dwordx4 v[96:99], v238, s[36:39], 0 offen sc1
    buffer_store_dwordx4 v[100:103], v238, s[36:39], s49 offen sc1
    s_branch L_slow_7_j
L_slow_8:
    buffer_store_dword v17, v16, s[36:39], s5 offen sc1
    s_branch L_slow_8_j
L_poll_9:
    s_add_u32 s51, s71, 0
    s_add_u32 s55, s55, 1
    buffer_load_dword v18, v239, s[36:39], s51 offen sc1
    s_cmp_gt_u32 s55, 400000
    s_waitcnt vmcnt(0)
    s_cbranch_scc1 L_poll_9_ok
    v_cmp_ne_u32 vcc, s3, v18
    s_and_b64 vcc, vcc, s[6:7]
    s_cbranch_vccnz L_poll_9
    s_branch L_poll_9_ok
L_slow_10:
    buffer_store_dwordx4 v[32:35], v227, s[36:39], s14 offen sc1
    s_branch L_slow_10_j
L_slow_12:
    buffer_store_dwordx4 v[72:75], v231, s[36:39], s12 offen sc1
    buffer_store_dwordx4 v[76:79], v231, s[36:39], s12 offen offset:2048 sc1
    s_branch L_slow_12_j
L_slow_13:
    buffer_store_dword v17, v16, s[36:39], s5 offen sc1
    s_branch L_slow_13_j
L_poll_14:
    s_add_u32 s51, s71, 4096
    s_add_u32 s55, s55, 1
    buffer_load_dword v18, v239, s[36:39], s51 offen sc1
    s_cmp_gt_u32 s55, 400000
    s_waitcnt vmcnt(0)
    s_cbranch_scc1 L_poll_14_ok
    v_cmp_ne_u32 vcc, s3, v18
    s_and_b64 vcc, vcc, s[6:7]
    s_cbranch_vccnz L_poll_14
    s_branch L_poll_14_ok
L_slow_15:
    buffer_store_dword v17, v16, s[36:39], s5 offen sc1
    s_branch L_slow_15_j
L_poll_16:
    s_add_u32 s51, s71, 8192
    s_add_u32 s55, s55, 1
    buffer_load_dword v18, v239, s[36:39], s51 offen sc1
    s_cmp_gt_u32 s55, 400000
    s_waitcnt vmcnt(0)
    s_cbranch_scc1 L_poll_16_ok
    v_cmp_ne_u32 vcc, s3, v18
    s_and_b64 vcc, vcc, s[14:15]
    s_cbranch_vccnz L_poll_16
    s_branch L_poll_16_ok
L_slow_17:
    buffer_store_dword v17, v16, s[36:39], s5 offen sc1
    s_branch L_slow_17_j
L_slow_18:
    buffer_store_dword v17, v16, s[36:39], s5 offen sc1
    s_branch L_slow_18_j
L_poll_19:
    s_add_u32 s51, s71, 12288
    s_add_u32 s55, s55, 1
    buffer_load_dword v19, v239, s[36:39], s51 offen sc1
    s_cmp_gt_u32 s55, 400000
    s_waitcnt vmcnt(0)
    s_cbranch_scc1 L_poll_19_ok
    v_cmp_ne_u32 vcc, s3, v19
    s_and_b64 vcc, vcc, s[14:15]
    s_cbranch_vccnz L_poll_19
    s_branch L_poll_19_ok
L_slow_20:
    buffer_store_dword v17, v16, s[36:39], s5 offen sc1
    s_branch L_slow_20_j
L_poll_21:
    s_add_u32 s51, s71, 24576
    s_add_u32 s55, s55, 1
    buffer_load_dword v18, v239, s[36:39], s51 offen sc1
    s_cmp_gt_u32 s55, 400000
    s_waitcnt vmcnt(0)
    s_cbranch_scc1 L_poll_21_ok
    v_cmp_ne_u32 vcc, s3, v18
    s_and_b64 vcc, vcc, s[14:15]
    s_cbranch_vccnz L_poll_21
    s_branch L_poll_21_ok
L_poll_22:
    s_add_u32 s51, s71, 32768
    s_add_u32 s55, s55, 1
    buffer_load_dword v19, v239, s[36:39], s51 offen sc1
    s_cmp_gt_u32 s55, 400000
    s_waitcnt vmcnt(0)
    s_cbranch_scc1 L_poll_22_ok
    v_cmp_ne_u32 vcc, s3, v19
    s_and_b64 vcc, vcc, s[14:15]
    s_cbranch_vccnz L_poll_22
    s_branch L_poll_22_ok
L_slow_23:
    buffer_store_dword v17, v16, s[36:39], s5 offen sc1
    s_branch L_slow_23_j
L_poll_24:
    s_add_u32 s51, s71, 16384
    s_add_u32 s55, s55, 1
    buffer_load_dword v18, v239, s[36:39], s51 offen sc1
    s_cmp_gt_u32 s55, 400000
    s_waitcnt vmcnt(0)
    s_cbranch_scc1 L_poll_24_ok
    v_cmp_ne_u32 vcc, s3, v18
    s_and_b64 vcc, vcc, s[16:17]
    s_cbranch_vccnz L_poll_24
    s_branch L_poll_24_ok
L_iw_25:
    s_lshl_b32 s49, s45, 1
    s_and_b32 s50, s46, 1
    s_add_u32 s49, s49, s50
    s_lshl_b32 s49, s49, 2
    s_add_u32 s49, s49, s42
    s_mul_i32 s49, s49, 7168
    s_add_u32 s49, s49, 917504
    s_mov_b32 exec_hi, 0x00ffffff
    buffer_load_dword v3, v2, s[20:23], s49 offen
    buffer_load_dword v3, v2, s[24:27], s49 offen
    s_mov_b64 exec, -1
    s_branch L_iw_25_j
L_poll_26:
    s_sleep 4
    s_add_u32 s51, s71, 8192
    s_add_u32 s55, s55, 1
    buffer_load_dword v18, v239, s[36:39], s51 offen sc1
    s_cmp_gt_u32 s55, 400000
    s_waitcnt vmcnt(0)
    s_cbranch_scc1 L_poll_26_ok
    v_cmp_ne_u32 vcc, s3, v18
    s_and_b64 vcc, vcc, s[14:15]
    s_cbranch_vccnz L_poll_26
    s_branch L_poll_26_ok
L_codeend:
.section .rodata,"a"
.p2align 6
.amdhsa_kernel sequential_preLN__sliding_local_dilated__glu_gated_swiglu__prompt_kernel
  .amdhsa_next_free_vgpr 512
  .amdhsa_next_free_sgpr 102
  .amdhsa_accum_offset 256
  .amdhsa_group_segment_fixed_size 0
  .amdhsa_kernarg_size 80
  .amdhsa_user_sgpr_count 2
  .amdhsa_user_sgpr_kernarg_segment_ptr 1
  .amdhsa_system_sgpr_workgroup_id_x 1
  .amdhsa_float_denorm_mode_32 3
.end_amdhsa_kernel
```
